```python
import torch

def _softmax(x, axis=-1):
    return torch.softmax(x, dim=axis)
def _gelu(x):
    return torch.nn.functional.gelu(x, approximate="tanh")
def _silu(x):
    return torch.nn.functional.silu(x)
def _sigmoid(x):
    return torch.sigmoid(x)
def _layernorm(x, axis=-1, eps=1e-5):
    m = x.mean(dim=axis, keepdim=True)
    v = x.var(dim=axis, keepdim=True, unbiased=False)
    return (x - m) / torch.sqrt(v + eps)
def _scatter_add(tgt, idx, src, axis=0):
    return tgt.clone().index_add_(axis, idx, src)
def _segment_sum(src, seg, n):
    out = torch.zeros((n,) + src.shape[1:], dtype=src.dtype)
    return out.index_add_(0, seg, src)
def _pad(x, pw):
    flat = tuple(v for pair in reversed(pw) for v in pair)
    return torch.nn.functional.pad(x, flat)

kernel_name = 'parallel_sum__sliding_block_cached__geglu_ffn__decode'

def setup_inputs():

    _w = (lambda a: (lambda t: t.to(torch.bfloat16) if t.is_floating_point() else t)(torch.as_tensor(a)))
    def _A_setup():
        B, Sq, D = 1, 1, 576
        Hq, Hkv, Sk, Dh = 32, 16, 65536, 128
        assert Hq % Hkv == 0, (Hq, Hkv)
        return {
            "x": _w((lambda *s: torch.randn(*s, dtype=torch.bfloat16) * 0.05)(B, Sq, D)),
            "k_cache": _w((lambda *s: torch.randn(*s, dtype=torch.bfloat16) * 3.2)(B, Hkv, Sk, Dh)),
            "v_cache": _w((lambda *s: torch.randn(*s, dtype=torch.bfloat16) * 1.6)(B, Hkv, Sk, Dh)),
            "wq": _w((lambda *s: torch.randn(*s, dtype=torch.bfloat16) * 3.2)(D, Hq * Dh) * (D ** -0.5)),
            "wo": _w((lambda *s: torch.randn(*s, dtype=torch.bfloat16) * 1.6)(Hq * Dh, D) * ((Hq * Dh) ** -0.5)),
        }
    _A_in = _A_setup()

    def _B_setup():
        B, S, D, F = 1, 1, 576, 4608
        return {
            "x": _w((lambda *s: torch.randn(*s, dtype=torch.bfloat16) * 0.05)(B, S, D)),
            "w_gate": _w((lambda *s: torch.randn(*s, dtype=torch.bfloat16) * 0.05)(D, F)),
            "w_up": _w((lambda *s: torch.randn(*s, dtype=torch.bfloat16) * 0.05)(D, F)),
            "w_down": _w((lambda *s: torch.randn(*s, dtype=torch.bfloat16) * 0.05)(F, D)),
        }
    _B_in = _B_setup()

    return {
        "A_x": _A_in["x"],
        "A_k_cache": _A_in["k_cache"],
        "A_v_cache": _A_in["v_cache"],
        "A_wq": _A_in["wq"],
        "A_wo": _A_in["wo"],
        "B_x": _B_in["x"],
        "B_w_gate": _B_in["w_gate"],
        "B_w_up": _B_in["w_up"],
        "B_w_down": _B_in["w_down"],
    }

def reference(A_x, A_k_cache, A_v_cache, A_wq, A_wo, B_x, B_w_gate, B_w_up, B_w_down):
    def _A_ref(x, k_cache, v_cache, wq, wo):
        B, Sq, D = x.shape
        Hq, Dh = 32, 128
        Hkv, Sk = k_cache.shape[1], k_cache.shape[2]
        W = min(4096, max(256, Sk // 4))
        rep = Hq // Hkv
        q = (lambda x, *d: x.permute(*d))((x @ wq).reshape(B, Sq, Hq, Dh), 0, 2, 1, 3)
        k = (lambda x, n, axis: torch.repeat_interleave(x, n, dim=axis))(k_cache[:, :, Sk - W:, :], rep, axis=1)
        v = (lambda x, n, axis: torch.repeat_interleave(x, n, dim=axis))(v_cache[:, :, Sk - W:, :], rep, axis=1)
        scores = torch.einsum("bhqd,bhkd->bhqk", q, k) * (Dh ** -0.5)
        p = _softmax(scores, axis=-1)
        o = torch.einsum("bhqk,bhkd->bhqd", p, v)
        return (lambda x, *d: x.permute(*d))(o, 0, 2, 1, 3).reshape(B, Sq, Hq * Dh) @ wo

    def _B_ref(x, w_gate, w_up, w_down):
        return (_gelu(x @ w_gate) * (x @ w_up)) @ w_down

    x = A_x
    xn = _layernorm(x, axis=-1)
    return x + _A_ref(xn, A_k_cache, A_v_cache, A_wq, A_wo) + _B_ref(xn, B_w_gate, B_w_up, B_w_down)
```

```asm
; @launch grid=(256,1,1) block=(1024,1,1) lds=77824
.amdgcn_target "amdgcn-amd-amdhsa--gfx950"
.text
.globl parallel_sum__sliding_block_cached__geglu_ffn__decode_kernel
.p2align 8
.type parallel_sum__sliding_block_cached__geglu_ffn__decode_kernel,@function
parallel_sum__sliding_block_cached__geglu_ffn__decode_kernel:
L_start:
    s_load_dwordx16 s[8:23], s[0:1], 0
    s_load_dwordx8 s[24:31], s[0:1], 64
    v_lshrrev_b32 v1, 6, v0
    s_cmp_ge_u32 s2, 256
    s_cbranch_scc1 L_end
    v_readfirstlane_b32 s3, v1
    v_and_b32 v0, 63, v0
    s_and_b32 s4, s2, 7
    s_lshr_b32 s5, s2, 3
    s_cmp_gt_u32 s3, 7
    s_cbranch_scc1 L_kv
    s_sub_u32 s3, s3, 1
    s_cbranch_scc0 L_p1
    s_getpc_b64 s[34:35]
    s_and_b32 s36, s5, 3
    s_mul_i32 s36, s36, 22
    v_min_u32 v2, 21, v0
    v_add_lshl_u32 v2, v2, s36, 7
    v_mov_b32 v3, 0
    v_lshl_add_u64 v[4:5], v[2:3], 0, s[34:35]
    global_load_dword v19, v[4:5], off offset:448
    v_lshlrev_b32 v1, 4, v0
    v_min_u32 v2, 112, v1
    s_waitcnt lgkmcnt(0)
    global_load_dwordx4 v[8:11], v1, s[8:9]
    global_load_dwordx4 v[12:15], v2, s[8:9] offset:1024
    s_load_dword s40, s[30:31], 0
    s_load_dwordx2 s[18:19], s[8:9], 0
    s_branch L_ln
L_p1:
    s_and_b32 s7, s5, 15
    s_lshr_b32 s6, s5, 4
    s_and_b32 s37, s5, 14
    s_add_u32 s37, s37, s3
    s_and_b32 s39, s5, 1
    s_lshl1_add_u32 s39, s6, s39
    s_and_b32 s36, s3, 1
    s_lshl1_add_u32 s36, s6, s36
    s_lshr_b32 s35, s3, 2
    s_cmp_eq_u32 s3, 6
    s_cselect_b32 s36, 4, s36
    s_cselect_b32 s6, s6, s35
    s_cmp_lt_u32 s3, 2
    s_cselect_b32 s35, 8, 9
    s_cselect_b32 s36, s39, s36
    s_cselect_b32 s7, s37, s7
    s_lshl_b32 s35, s35, 7
    s_lshl_b32 s36, s36, 8
    s_mul_i32 s37, s7, 288
    s_lshl_b32 s38, s35, 5
    s_add_u32 s37, s37, s4
    s_mul_i32 s37, s37, s35
    s_add_u32 s37, s37, s36
    v_lshrrev_b32 v1, 1, v0
    v_and_b32 v1, 24, v1
    v_and_b32 v2, 15, v0
    v_mul_u32_u24 v1, s35, v1
    v_lshl_add_u32 v2, v2, 4, s37
    v_add_u32 v8, v1, v2
    v_add_u32 v9, s38, v8
    v_add_u32 v10, s38, v9
    v_add_u32 v11, s38, v10
    v_add_u32 v12, s38, v11
    v_add_u32 v13, s38, v12
    v_add_u32 v14, s38, v13
    v_add_u32 v15, s38, v14
    v_add_u32 v16, s38, v15
    s_cmp_eq_u32 s3, 6
    s_cselect_b32 s34, 0x00ff00ff, -1
    s_mov_b32 exec_lo, s34
    s_mov_b32 exec_hi, s34
    s_cmp_eq_u32 s6, 0
    s_waitcnt lgkmcnt(0)
    s_cselect_b64 s[42:43], s[20:21], s[22:23]
    s_cmp_lt_u32 s3, 2
    s_cselect_b64 s[42:43], s[14:15], s[42:43]
    global_load_dwordx4 v[56:59], v8, s[42:43] nt
    global_load_dwordx4 v[60:63], v9, s[42:43] nt
    global_load_dwordx4 v[64:67], v10, s[42:43] nt
    global_load_dwordx4 v[68:71], v11, s[42:43] nt
    global_load_dwordx4 v[72:75], v12, s[42:43] nt
    global_load_dwordx4 v[76:79], v13, s[42:43] nt
    global_load_dwordx4 v[80:83], v14, s[42:43] nt
    global_load_dwordx4 v[84:87], v15, s[42:43] nt
    global_load_dwordx4 v[88:91], v16, s[42:43] nt
    s_barrier
    s_mov_b64 exec, -1
    s_load_dword s40, s[30:31], 0
    s_load_dwordx2 s[18:19], s[8:9], 0
    s_mov_b32 s35, 0
    v_lshrrev_b32 v2, 4, v0
    s_mul_i32 s37, s7, 144
    v_lshl_add_u32 v19, v2, 2, s37
    ds_read_b32 v8, v19 offset:832
    ds_read_b32 v9, v19 offset:848
    ds_read_b32 v10, v19 offset:864
    ds_read_b32 v11, v19 offset:880
    ds_read_b32 v12, v19 offset:896
    ds_read_b32 v13, v19 offset:912
    ds_read_b32 v14, v19 offset:928
    ds_read_b32 v15, v19 offset:944
    ds_read_b32 v16, v19 offset:960
    v_and_b32 v4, 1, v0
    v_lshlrev_b32 v4, 4, v4
    v_mov_b32 v5, 0xffff
    v_lshlrev_b32 v3, v4, v5
    v_bfe_u32 v2, v0, 1, 2
    v_cmp_eq_u32 vcc, 0, v2
    s_nop 1
    v_cndmask_b32 v4, 0, v3, vcc
    v_cmp_eq_u32 vcc, 1, v2
    s_nop 1
    v_cndmask_b32 v5, 0, v3, vcc
    v_cmp_eq_u32 vcc, 2, v2
    s_nop 1
    v_cndmask_b32 v6, 0, v3, vcc
    v_cmp_eq_u32 vcc, 3, v2
    s_nop 1
    v_cndmask_b32 v7, 0, v3, vcc
    s_mov_b32 s44, 0x07060500
    s_mov_b32 s45, 0x07060501
    s_mov_b32 s46, 0x07060502
    s_mov_b32 s47, 0x07060503
    s_mov_b32 s48, 0xffffff00
    s_mov_b32 s49, 0x0c0c0400
    s_mov_b32 s50, 0x04000c0c
    v_mov_b32 v1, 0
    s_mul_i32 s32, s4, 123520
    s_lshl_b32 s38, s36, 1
    s_lshr_b32 s37, s7, 1
    s_lshl3_add_u32 s36, s39, s37
    s_lshl_b32 s36, s36, 9
    s_add_u32 s36, s36, 4096
    s_lshl4_add_u32 s37, s6, s7
    s_mul_i32 s37, s37, 2304
    s_add_u32 s37, s37, s38
    s_add_u32 s37, s37, 20480
    s_cmp_lt_u32 s3, 2
    s_cselect_b32 s36, s36, s37
    s_add_u32 s36, s36, s32
    v_and_b32 v2, 15, v0
    v_lshlrev_b32 v2, 5, v2
    v_and_b32 v3, 16, v0
    v_add3_u32 v18, v2, v3, s36
    s_movk_i32 s41, 0x80
    v_mov_b32 v32, 1
    s_waitcnt lgkmcnt(0)
    s_add_u32 s40, s40, 0x9e3779b9
    s_or_b32 s40, s40, 1
    s_mul_i32 s18, s18, 0x85ebca6b
    s_add_u32 s18, s18, s19
    s_mul_i32 s18, s18, 0xc2b2ae35
    s_and_b32 s18, s18, 0xffffff00
    s_add_u32 s40, s40, s18
    v_mov_b32 v17, s40
    v_and_b32 v92, v8, v4
    v_and_b32 v93, v8, v5
    v_and_b32 v94, v8, v6
    v_and_b32 v95, v8, v7
    v_and_b32 v96, v9, v4
    v_and_b32 v97, v9, v5
    v_and_b32 v98, v9, v6
    v_and_b32 v99, v9, v7
    v_and_b32 v100, v10, v4
    v_and_b32 v101, v10, v5
    v_and_b32 v102, v10, v6
    v_and_b32 v103, v10, v7
    v_and_b32 v104, v11, v4
    v_and_b32 v105, v11, v5
    v_and_b32 v106, v11, v6
    v_and_b32 v107, v11, v7
    v_and_b32 v108, v12, v4
    v_and_b32 v109, v12, v5
    v_and_b32 v110, v12, v6
    v_and_b32 v111, v12, v7
    v_and_b32 v112, v13, v4
    v_and_b32 v113, v13, v5
    v_and_b32 v114, v13, v6
    v_and_b32 v115, v13, v7
    v_and_b32 v116, v14, v4
    v_and_b32 v117, v14, v5
    v_and_b32 v118, v14, v6
    v_and_b32 v119, v14, v7
    v_and_b32 v120, v15, v4
    v_and_b32 v121, v15, v5
    v_and_b32 v122, v15, v6
    v_and_b32 v123, v15, v7
    v_and_b32 v124, v16, v4
    v_and_b32 v125, v16, v5
    v_and_b32 v126, v16, v6
    v_and_b32 v127, v16, v7
    s_cmp_lt_u32 s3, 2
    s_waitcnt vmcnt(8)
    v_mfma_f32_16x16x32_bf16 v[28:31], v[92:95], v[56:59], 0
    s_waitcnt vmcnt(7)
    v_mfma_f32_16x16x32_bf16 v[28:31], v[96:99], v[60:63], v[28:31]
    s_waitcnt vmcnt(6)
    v_mfma_f32_16x16x32_bf16 v[28:31], v[100:103], v[64:67], v[28:31]
    s_waitcnt vmcnt(5)
    v_mfma_f32_16x16x32_bf16 v[28:31], v[104:107], v[68:71], v[28:31]
    s_waitcnt vmcnt(4)
    v_mfma_f32_16x16x32_bf16 v[28:31], v[108:111], v[72:75], v[28:31]
    s_waitcnt vmcnt(3)
    v_mfma_f32_16x16x32_bf16 v[28:31], v[112:115], v[76:79], v[28:31]
    s_waitcnt vmcnt(2)
    v_mfma_f32_16x16x32_bf16 v[28:31], v[116:119], v[80:83], v[28:31]
    s_waitcnt vmcnt(1)
    v_mfma_f32_16x16x32_bf16 v[28:31], v[120:123], v[84:87], v[28:31]
    s_waitcnt vmcnt(0)
    v_mfma_f32_16x16x32_bf16 v[28:31], v[124:127], v[88:91], v[28:31]
    s_cbranch_scc0 L_np
    s_lshl_b32 s36, s3, 10
    v_lshl_add_u32 v2, v0, 4, s36
    s_lshl_b32 s36, s3, 3
    s_lshl_b32 s34, 0x00ff00ff, s36
    v_xor_b32 v8, 0x400, v2
    s_nop 1
    ds_write_b128 v2, v[28:31] offset:3136
    s_mov_b64 exec, 1
    ds_add_u32 v1, v32 offset:48
    s_mov_b64 exec, -1
    s_mov_b32 s54, 0
L_sw:
    ds_read_b32 v3, v1 offset:48
    s_add_u32 s54, s54, 1
    s_waitcnt lgkmcnt(0)
    v_readfirstlane_b32 s55, v3
    s_cmp_ge_u32 s55, 2
    s_cbranch_scc1 L_sw_ok
    s_sleep 1
    s_cmp_lt_u32 s54, 131072
    s_cbranch_scc1 L_sw
L_sw_ok:
    ds_read_b128 v[8:11], v8 offset:3136
    s_waitcnt lgkmcnt(0)
    v_add_f32 v28, v28, v8
    v_add_f32 v29, v29, v9
    v_add_f32 v30, v30, v10
    v_add_f32 v31, v31, v11
L_np:
    s_nop 6
    v_add_u32 v28, s41, v28
    v_add_u32 v29, s41, v29
    v_add_u32 v30, s41, v30
    v_add_u32 v31, s41, v31
    v_perm_b32 v28, v28, v17, s44
    v_perm_b32 v29, v29, v17, s45
    v_perm_b32 v30, v30, v17, s46
    v_perm_b32 v31, v31, v17, s47
    s_mov_b64 exec, s[34:35]
    global_store_dwordx4 v18, v[28:31], s[30:31]
    s_mov_b64 exec, -1
    s_mov_b64 exec, 1
    ds_add_u32 v1, v32 offset:60
    s_mov_b64 exec, -1
    s_cmp_ge_u32 s3, 5
    s_cbranch_scc1 L_qw
    s_cmp_lt_u32 s3, 2
    s_cselect_b32 s36, 48, 28
    v_mov_b32 v2, s36
    s_mov_b64 exec, 1
    s_cbranch_scc0 L_ng
    ds_add_u32 v1, v32 offset:24
L_ng:
    s_waitcnt vmcnt(0)
    ds_add_u32 v2, v32
    s_mov_b64 exec, -1
    s_cmp_eq_u32 s3, 0
    s_cbranch_scc0 L_nx
    s_getreg_b32 s41, hwreg(HW_REG_XCC_ID, 0, 4)
    s_and_b32 s36, s40, 0xfffffff0
    s_or_b32 s41, s36, s41
    s_add_u32 s36, s32, 127488
    v_and_b32 v3, 31, v0
    v_lshl_add_u32 v8, v3, 2, s36
    s_mov_b32 s54, 0
L_xg:
    global_load_dword v2, v8, s[30:31] sc1 nt
    s_add_u32 s54, s54, 1
    s_waitcnt vmcnt(0)
    v_xor_b32 v3, s40, v2
    v_cmp_gt_u32 s[52:53], 16, v3
    v_cmp_eq_u32 vcc, s41, v2
    s_mov_b32 s55, 2
    s_cmp_eq_u64 vcc, s[52:53]
    s_cbranch_scc0 L_xg_far
    s_or_b32 s36, vcc_lo, vcc_hi
    s_mov_b32 s55, 1
    s_cmp_eq_u32 s36, -1
    s_cbranch_scc1 L_xg_ok
    s_cmp_eq_u32 s54, 3
    s_cbranch_scc1 L_xg_far
    s_cmp_lt_u32 s54, 131072
    s_cbranch_scc1 L_xg
L_xg_ok:
    v_mov_b32 v2, s55
    ds_write_b32 v1, v2 offset:40
L_nx:
    s_mov_b32 s54, 0
L_sm0:
    ds_read_b32 v3, v1 offset:40
    s_add_u32 s54, s54, 1
    s_waitcnt lgkmcnt(0)
    v_readfirstlane_b32 s55, v3
    s_cmp_ge_u32 s55, 1
    s_cbranch_scc1 L_sm0_ok
    s_sleep 4
    s_cmp_lt_u32 s54, 131072
    s_cbranch_scc1 L_sm0
L_sm0_ok:
    s_cmp_eq_u32 s55, 2
    s_cbranch_scc0 L_rp0
    v_add_u32 v19, 1048576, v18
    s_mov_b64 exec, s[34:35]
    global_store_dwordx4 v19, v[28:31], s[30:31] sc1
    s_mov_b64 exec, -1
L_rp0:
    s_waitcnt vmcnt(0)
    s_mov_b64 exec, 1
    ds_add_u32 v1, v32 offset:44
    s_mov_b64 exec, -1
    s_mov_b32 s51, s55
    s_cmp_eq_u32 s55, 2
    s_cselect_b32 s36, 1048576, 0
    s_add_u32 s32, s32, s36
    s_mul_i32 s41, s5, 165888
    s_add_u32 s56, s24, s41
    s_addc_u32 s57, s25, 0
    s_mov_b32 s58, 165888
    s_mov_b32 s59, 0x20000
    s_lshl_b32 s41, s5, 7
    s_add_u32 s41, s41, 2127872
    s_add_u32 s6, s30, s41
    s_addc_u32 s7, s31, 0
    s_lshl_b32 s33, s4, 5
    s_add_u32 s33, s33, s5
    s_mul_i32 s41, s33, 18432
    s_add_u32 s60, s16, s41
    s_addc_u32 s61, s17, 0
    s_movk_i32 s62, 0x4800
    s_mov_b32 s63, 0x20000
    v_lshrrev_b32 v3, 4, v0
    v_mul_u32_u24 v2, 1152, v3
    v_and_b32 v8, 15, v0
    v_lshl_add_u32 v2, v8, 4, v2
    s_lshl_b32 s36, s3, 8
    v_add_u32 v10, s36, v2
    s_cmp_eq_u32 s3, 4
    s_cselect_b32 s34, 0x00ff00ff, -1
    v_lshlrev_b32 v8, 2, v3
    v_add_u32 v8, 11328, v8
    v_and_b32 v2, 14, v0
    v_add_u32 v2, v2, v3
    v_lshlrev_b32 v2, 10, v2
    v_and_b32 v3, 1, v0
    v_lshlrev_b32 v3, 4, v3
    s_lshl_b32 s37, s3, 14
    s_add_u32 s37, s37, s32
    s_lshl_b32 s38, s5, 5
    s_add_u32 s37, s37, s38
    s_add_u32 s37, s37, 20480
    v_add3_u32 v13, v2, v3, s37
    s_not_b32 s41, s40
    s_bfe_u32 s44, s41, 65536
    s_bfe_u32 s45, s41, 65544
    s_bfe_u32 s46, s41, 65552
    s_bfe_u32 s47, s41, 65560
    v_lshrrev_b32 v3, 4, v0
    v_lshlrev_b32 v9, 4, v3
    s_lshl_b32 s37, s5, 10
    s_add_u32 s37, s37, s32
    s_add_u32 s37, s37, 94208
    v_lshl_add_u32 v14, v0, 4, s37
    v_and_b32 v15, 60, v0
    s_movk_i32 s36, 4608
    s_movk_i32 s37, 9216
    s_movk_i32 s38, 13824
    s_mov_b32 s39, 0
    v_mov_b32 v28, 0
    v_mov_b32 v29, 0
    v_mov_b32 v30, 0
    v_mov_b32 v31, 0
    s_mov_b32 s54, 0
L_skv:
    ds_read_b32 v3, v1 offset:52
    s_add_u32 s54, s54, 1
    s_waitcnt lgkmcnt(0)
    v_readfirstlane_b32 s55, v3
    s_cmp_ge_u32 s55, 8
    s_cbranch_scc1 L_skv_ok
    s_sleep 1
    s_cmp_lt_u32 s54, 131072
    s_cbranch_scc1 L_skv
L_skv_ok:
    s_mov_b32 s54, 0
L_sst:
    ds_read_b32 v3, v1 offset:88
    s_add_u32 s54, s54, 1
    s_waitcnt lgkmcnt(0)
    v_readfirstlane_b32 s55, v3
    s_cmp_ge_u32 s55, 1
    s_cbranch_scc1 L_sst_ok
    s_sleep 1
    s_cmp_lt_u32 s54, 8
    s_cbranch_scc1 L_sst
L_sst_ok:
    s_mov_b32 s54, 0
L_swm:
    ds_read_b32 v3, v1 offset:32
    s_add_u32 s54, s54, 1
    s_waitcnt lgkmcnt(0)
    v_readfirstlane_b32 s55, v3
    s_cmp_ge_u32 s55, 3
    s_cbranch_scc1 L_swm_ok
    s_sleep 1
    s_cmp_lt_u32 s54, 131072
    s_cbranch_scc1 L_swm
L_swm_ok:
    s_mov_b32 exec_lo, s34
    s_mov_b32 exec_hi, s34
    buffer_load_dwordx4 v[112:115], v10, s[60:63], 0 offen nt
    buffer_load_dwordx4 v[116:119], v10, s[60:63], s36 offen nt
    buffer_load_dwordx4 v[120:123], v10, s[60:63], s37 offen nt
    buffer_load_dwordx4 v[124:127], v10, s[60:63], s38 offen nt
    s_cmp_eq_u32 s3, 0
    s_cbranch_scc0 L_dw0
    s_mov_b32 s54, 0
L_dp0:
    ds_read_b32 v3, v1 offset:32
    s_add_u32 s54, s54, 1
    s_waitcnt lgkmcnt(0)
    v_readfirstlane_b32 s55, v3
    s_cmp_ge_u32 s55, 5
    s_cbranch_scc1 L_dp0_ok
    s_sleep 1
    s_cmp_lt_u32 s54, 131072
    s_cbranch_scc1 L_dp0
L_dp0_ok:
    s_mov_b32 s54, 0
L_da0:
    s_mov_b32 s55, 1
    s_atomic_add s55, s[6:7], 0 glc
    s_add_u32 s54, s54, 1
    s_waitcnt lgkmcnt(0)
    s_sub_u32 s55, s55, s40
    s_cmp_lt_u32 s55, 64
    s_cbranch_scc1 L_db0
    s_cmp_lt_u32 s54, 131072
    s_cbranch_scc1 L_da0
L_db0:
    s_add_u32 s55, s55, 1
    v_mov_b32 v2, s55
    ds_write_b32 v1, v2 offset:64
    s_branch L_ds0_ok
L_dw0:
    s_mov_b32 s54, 0
L_ds0:
    ds_read_b32 v3, v1 offset:64
    s_add_u32 s54, s54, 1
    s_waitcnt lgkmcnt(0)
    v_readfirstlane_b32 s55, v3
    s_cmp_ge_u32 s55, 1
    s_cbranch_scc1 L_ds0_ok
    s_sleep 1
    s_cmp_lt_u32 s54, 131072
    s_cbranch_scc1 L_ds0
L_ds0_ok:
    s_cmp_gt_u32 s55, 18
    s_cbranch_scc1 L_dd
    s_sub_u32 s55, s55, 1
    s_mul_i32 s36, s55, 9216
    s_add_u32 s37, s36, 4608
    buffer_load_dwordx4 v[64:67], v10, s[56:59], s36 offen nt
    buffer_load_dwordx4 v[68:71], v10, s[56:59], s37 offen nt
    s_lshl_b32 s8, s55, 5
    s_mov_b32 s39, 1
    s_mov_b32 s9, s8
    s_mov_b32 s10, s8
    s_mov_b32 s11, s8
    s_mov_b32 s12, s8
    s_cmp_ge_u32 s55, 14
    s_cbranch_scc1 L_dd
    s_cmp_eq_u32 s3, 0
    s_cbranch_scc0 L_dw1
    s_mov_b32 s54, 0
L_dp1:
    ds_read_b32 v3, v1 offset:32
    s_add_u32 s54, s54, 1
    s_waitcnt lgkmcnt(0)
    v_readfirstlane_b32 s55, v3
    s_cmp_ge_u32 s55, 7
    s_cbranch_scc1 L_dp1_ok
    s_sleep 1
    s_cmp_lt_u32 s54, 131072
    s_cbranch_scc1 L_dp1
L_dp1_ok:
    s_mov_b32 s54, 0
L_da1:
    s_mov_b32 s55, 1
    s_atomic_add s55, s[6:7], 0 glc
    s_add_u32 s54, s54, 1
    s_waitcnt lgkmcnt(0)
    s_sub_u32 s55, s55, s40
    s_cmp_lt_u32 s55, 64
    s_cbranch_scc1 L_db1
    s_cmp_lt_u32 s54, 131072
    s_cbranch_scc1 L_da1
L_db1:
    s_add_u32 s55, s55, 1
    v_mov_b32 v2, s55
    ds_write_b32 v1, v2 offset:68
    s_branch L_ds1_ok
L_dw1:
    s_mov_b32 s54, 0
L_ds1:
    ds_read_b32 v3, v1 offset:68
    s_add_u32 s54, s54, 1
    s_waitcnt lgkmcnt(0)
    v_readfirstlane_b32 s55, v3
    s_cmp_ge_u32 s55, 1
    s_cbranch_scc1 L_ds1_ok
    s_sleep 1
    s_cmp_lt_u32 s54, 131072
    s_cbranch_scc1 L_ds1
L_ds1_ok:
    s_cmp_gt_u32 s55, 18
    s_cbranch_scc1 L_dd
    s_sub_u32 s55, s55, 1
    s_mul_i32 s36, s55, 9216
    s_add_u32 s37, s36, 4608
    buffer_load_dwordx4 v[72:75], v10, s[56:59], s36 offen nt
    buffer_load_dwordx4 v[76:79], v10, s[56:59], s37 offen nt
    s_lshl_b32 s9, s55, 5
    s_mov_b32 s39, 2
    s_cmp_ge_u32 s55, 14
    s_cbranch_scc1 L_dd
    s_cmp_eq_u32 s3, 0
    s_cbranch_scc0 L_dw2
    s_waitcnt vmcnt(7)
    s_mov_b32 s54, 0
L_da2:
    s_mov_b32 s55, 1
    s_atomic_add s55, s[6:7], 0 glc
    s_add_u32 s54, s54, 1
    s_waitcnt lgkmcnt(0)
    s_sub_u32 s55, s55, s40
    s_cmp_lt_u32 s55, 64
    s_cbranch_scc1 L_db2
    s_cmp_lt_u32 s54, 131072
    s_cbranch_scc1 L_da2
L_db2:
    s_add_u32 s55, s55, 1
    v_mov_b32 v2, s55
    ds_write_b32 v1, v2 offset:72
    s_branch L_ds2_ok
L_dw2:
    s_mov_b32 s54, 0
L_ds2:
    ds_read_b32 v3, v1 offset:72
    s_add_u32 s54, s54, 1
    s_waitcnt lgkmcnt(0)
    v_readfirstlane_b32 s55, v3
    s_cmp_ge_u32 s55, 1
    s_cbranch_scc1 L_ds2_ok
    s_sleep 1
    s_cmp_lt_u32 s54, 131072
    s_cbranch_scc1 L_ds2
L_ds2_ok:
    s_cmp_gt_u32 s55, 18
    s_cbranch_scc1 L_dd
    s_sub_u32 s55, s55, 1
    s_mul_i32 s36, s55, 9216
    s_add_u32 s37, s36, 4608
    buffer_load_dwordx4 v[80:83], v10, s[56:59], s36 offen nt
    buffer_load_dwordx4 v[84:87], v10, s[56:59], s37 offen nt
    s_lshl_b32 s10, s55, 5
    s_mov_b32 s39, 3
    s_cmp_ge_u32 s55, 14
    s_cbranch_scc1 L_dd
    s_cmp_eq_u32 s3, 0
    s_cbranch_scc0 L_dw3
    s_waitcnt vmcnt(7)
    s_mov_b32 s54, 0
L_da3:
    s_mov_b32 s55, 1
    s_atomic_add s55, s[6:7], 0 glc
    s_add_u32 s54, s54, 1
    s_waitcnt lgkmcnt(0)
    s_sub_u32 s55, s55, s40
    s_cmp_lt_u32 s55, 64
    s_cbranch_scc1 L_db3
    s_cmp_lt_u32 s54, 131072
    s_cbranch_scc1 L_da3
L_db3:
    s_add_u32 s55, s55, 1
    v_mov_b32 v2, s55
    ds_write_b32 v1, v2 offset:76
    s_branch L_ds3_ok
L_dw3:
    s_mov_b32 s54, 0
L_ds3:
    ds_read_b32 v3, v1 offset:76
    s_add_u32 s54, s54, 1
    s_waitcnt lgkmcnt(0)
    v_readfirstlane_b32 s55, v3
    s_cmp_ge_u32 s55, 1
    s_cbranch_scc1 L_ds3_ok
    s_sleep 1
    s_cmp_lt_u32 s54, 131072
    s_cbranch_scc1 L_ds3
L_ds3_ok:
    s_cmp_gt_u32 s55, 18
    s_cbranch_scc1 L_dd
    s_sub_u32 s55, s55, 1
    s_mul_i32 s36, s55, 9216
    s_add_u32 s37, s36, 4608
    buffer_load_dwordx4 v[88:91], v10, s[56:59], s36 offen nt
    buffer_load_dwordx4 v[92:95], v10, s[56:59], s37 offen nt
    s_lshl_b32 s11, s55, 5
    s_mov_b32 s39, 4
    s_cmp_ge_u32 s55, 14
    s_cbranch_scc1 L_dd
    s_cmp_eq_u32 s3, 0
    s_cbranch_scc0 L_dw4
    s_waitcnt vmcnt(7)
    s_mov_b32 s54, 0
L_da4:
    s_mov_b32 s55, 1
    s_atomic_add s55, s[6:7], 0 glc
    s_add_u32 s54, s54, 1
    s_waitcnt lgkmcnt(0)
    s_sub_u32 s55, s55, s40
    s_cmp_lt_u32 s55, 64
    s_cbranch_scc1 L_db4
    s_cmp_lt_u32 s54, 131072
    s_cbranch_scc1 L_da4
L_db4:
    s_add_u32 s55, s55, 1
    v_mov_b32 v2, s55
    ds_write_b32 v1, v2 offset:80
    s_branch L_ds4_ok
L_dw4:
    s_mov_b32 s54, 0
L_ds4:
    ds_read_b32 v3, v1 offset:80
    s_add_u32 s54, s54, 1
    s_waitcnt lgkmcnt(0)
    v_readfirstlane_b32 s55, v3
    s_cmp_ge_u32 s55, 1
    s_cbranch_scc1 L_ds4_ok
    s_sleep 1
    s_cmp_lt_u32 s54, 131072
    s_cbranch_scc1 L_ds4
L_ds4_ok:
    s_cmp_gt_u32 s55, 18
    s_cbranch_scc1 L_dd
    s_sub_u32 s55, s55, 1
    s_mul_i32 s36, s55, 9216
    s_add_u32 s37, s36, 4608
    buffer_load_dwordx4 v[96:99], v10, s[56:59], s36 offen nt
    buffer_load_dwordx4 v[100:103], v10, s[56:59], s37 offen nt
    s_lshl_b32 s12, s55, 5
    s_mov_b32 s39, 5
L_dd:
    s_mov_b64 exec, -1
    s_setprio 3
    s_mov_b32 s41, 0
    s_cmp_eq_u32 s39, 0
    s_cbranch_scc1 L_t0
    v_add_u32 v48, s8, v8
    v_add_u32 v49, s9, v8
    v_add_u32 v50, s10, v8
    v_add_u32 v51, s11, v8
    v_add_u32 v52, s12, v8
    s_mov_b32 s54, 0
L_sh:
    ds_read2_b32 v[32:33], v48 offset0:0 offset1:4
    ds_read2_b32 v[34:35], v49 offset0:0 offset1:4
    ds_read2_b32 v[36:37], v50 offset0:0 offset1:4
    ds_read2_b32 v[38:39], v51 offset0:0 offset1:4
    ds_read2_b32 v[40:41], v52 offset0:0 offset1:4
    s_add_u32 s54, s54, 1
    s_waitcnt lgkmcnt(0)
    v_max_u32 v2, v32, v33
    v_max3_u32 v2, v2, v34, v35
    v_max3_u32 v2, v2, v36, v37
    v_max3_u32 v2, v2, v38, v39
    v_max3_u32 v2, v2, v40, v41
    v_cmp_eq_u32 vcc, -1, v2
    s_cbranch_vccz L_sh_ok
    s_sleep 1
    s_cmp_lt_u32 s54, 131072
    s_cbranch_scc1 L_sh
L_sh_ok:
    s_waitcnt vmcnt(2)
    v_and_b32 v20, v32, v4
    v_and_b32 v21, v32, v5
    v_and_b32 v22, v32, v6
    v_and_b32 v23, v32, v7
    v_and_b32 v24, v33, v4
    v_and_b32 v25, v33, v5
    v_and_b32 v26, v33, v6
    v_and_b32 v27, v33, v7
    s_cmp_eq_u32 s39, 1
    s_cbranch_scc0 L_tn0
    s_call_b64 s[42:43], L_try
    s_waitcnt vmcnt(1)
    s_cmp_eq_u32 s39, 1
L_tn0:
    v_mfma_f32_16x16x32_bf16 v[28:31], v[20:23], v[64:67], v[28:31]
    v_mfma_f32_16x16x32_bf16 v[28:31], v[24:27], v[68:71], v[28:31]
    s_cbranch_scc1 L_tl
    v_and_b32 v20, v34, v4
    v_and_b32 v21, v34, v5
    v_and_b32 v22, v34, v6
    v_and_b32 v23, v34, v7
    v_and_b32 v24, v35, v4
    v_and_b32 v25, v35, v5
    v_and_b32 v26, v35, v6
    v_and_b32 v27, v35, v7
    s_cmp_eq_u32 s39, 2
    s_cbranch_scc0 L_tn1
    s_call_b64 s[42:43], L_try
    s_waitcnt vmcnt(1)
    s_cmp_eq_u32 s39, 2
L_tn1:
    v_mfma_f32_16x16x32_bf16 v[28:31], v[20:23], v[72:75], v[28:31]
    v_mfma_f32_16x16x32_bf16 v[28:31], v[24:27], v[76:79], v[28:31]
    s_cbranch_scc1 L_tl
    v_and_b32 v20, v36, v4
    v_and_b32 v21, v36, v5
    v_and_b32 v22, v36, v6
    v_and_b32 v23, v36, v7
    v_and_b32 v24, v37, v4
    v_and_b32 v25, v37, v5
    v_and_b32 v26, v37, v6
    v_and_b32 v27, v37, v7
    s_cmp_eq_u32 s39, 3
    s_cbranch_scc0 L_tn2
    s_call_b64 s[42:43], L_try
    s_waitcnt vmcnt(1)
    s_cmp_eq_u32 s39, 3
L_tn2:
    v_mfma_f32_16x16x32_bf16 v[28:31], v[20:23], v[80:83], v[28:31]
    v_mfma_f32_16x16x32_bf16 v[28:31], v[24:27], v[84:87], v[28:31]
    s_cbranch_scc1 L_tl
    v_and_b32 v20, v38, v4
    v_and_b32 v21, v38, v5
    v_and_b32 v22, v38, v6
    v_and_b32 v23, v38, v7
    v_and_b32 v24, v39, v4
    v_and_b32 v25, v39, v5
    v_and_b32 v26, v39, v6
    v_and_b32 v27, v39, v7
    s_cmp_eq_u32 s39, 4
    s_cbranch_scc0 L_tn3
    s_call_b64 s[42:43], L_try
    s_waitcnt vmcnt(1)
    s_cmp_eq_u32 s39, 4
L_tn3:
    v_mfma_f32_16x16x32_bf16 v[28:31], v[20:23], v[88:91], v[28:31]
    v_mfma_f32_16x16x32_bf16 v[28:31], v[24:27], v[92:95], v[28:31]
    s_cbranch_scc1 L_tl
    v_and_b32 v20, v40, v4
    v_and_b32 v21, v40, v5
    v_and_b32 v22, v40, v6
    v_and_b32 v23, v40, v7
    v_and_b32 v24, v41, v4
    v_and_b32 v25, v41, v5
    v_and_b32 v26, v41, v6
    v_and_b32 v27, v41, v7
    s_call_b64 s[42:43], L_try
    s_waitcnt vmcnt(1)
    v_mfma_f32_16x16x32_bf16 v[28:31], v[20:23], v[96:99], v[28:31]
    v_mfma_f32_16x16x32_bf16 v[28:31], v[24:27], v[100:103], v[28:31]
L_tl:
    s_cmp_eq_u32 s41, 1
    s_cbranch_scc1 L_wd
    s_mov_b32 s54, 0
L_so:
    global_load_dwordx4 v[108:111], v14, s[30:31] sc1 nt
    ds_read_b32 v16, v15 offset:11968
    s_waitcnt vmcnt(1)
    v_perm_b32 v2, v105, v104, s49
    v_perm_b32 v3, v107, v106, s50
    v_or_b32 v2, v2, v3
    v_cmp_eq_u32 vcc, s40, v2
    v_and_b32 v40, s48, v104
    v_and_b32 v41, s48, v105
    v_and_b32 v42, s48, v106
    v_and_b32 v43, s48, v107
    s_cmp_eq_u64 vcc, -1
    s_cbranch_scc1 L_so_w
    global_load_dwordx4 v[104:107], v14, s[30:31] sc1 nt
    ds_read_b32 v16, v15 offset:11968
    s_waitcnt vmcnt(1)
    v_perm_b32 v2, v109, v108, s49
    v_perm_b32 v3, v111, v110, s50
    v_or_b32 v2, v2, v3
    v_cmp_eq_u32 vcc, s40, v2
    v_and_b32 v40, s48, v108
    v_and_b32 v41, s48, v109
    v_and_b32 v42, s48, v110
    v_and_b32 v43, s48, v111
    s_cmp_eq_u64 vcc, -1
    s_cbranch_scc1 L_so_w
    s_add_u32 s54, s54, 1
    s_cmp_lt_u32 s54, 131072
    s_cbranch_scc1 L_so
L_sw2:
    ds_read_b32 v16, v15 offset:11968
    s_add_u32 s54, s54, 1
L_so_w:
    s_waitcnt lgkmcnt(0)
    v_cmp_eq_u32 vcc, 1, v16
    s_cbranch_vccz L_sw2_ok
    s_cmp_lt_u32 s54, 1048576
    s_cbranch_scc1 L_sw2
L_sw2_ok:
    v_mul_f32 v40, v40, v16
    v_mul_f32 v41, v41, v16
    v_mul_f32 v42, v42, v16
    v_mul_f32 v43, v43, v16
L_so_ok:
    s_nop 0
    v_permlane32_swap_b32 v40, v42
    v_permlane32_swap_b32 v41, v43
    v_add_f32 v40, v40, v42
    v_add_f32 v41, v41, v43
    s_nop 1
    v_permlane16_swap_b32 v40, v41
    v_add_f32 v40, v40, v41
    s_nop 1
    v_add_f32_dpp v40, v40, v40 row_ror:4 row_mask:0xf bank_mask:0xf
    s_nop 1
    v_add_f32_dpp v40, v40, v40 row_ror:8 row_mask:0xf bank_mask:0xf
    v_cvt_pk_bf16_f32 v40, v40, v40
    s_nop 1
    v_and_b32_dpp v48, v40, v4 quad_perm:[0,0,0,0] row_mask:0xf bank_mask:0xf
    v_and_b32_dpp v49, v40, v5 quad_perm:[0,0,0,0] row_mask:0xf bank_mask:0xf
    v_and_b32_dpp v50, v40, v6 quad_perm:[0,0,0,0] row_mask:0xf bank_mask:0xf
    v_and_b32_dpp v51, v40, v7 quad_perm:[0,0,0,0] row_mask:0xf bank_mask:0xf
    v_and_b32_dpp v52, v40, v4 quad_perm:[1,1,1,1] row_mask:0xf bank_mask:0xf
    v_and_b32_dpp v53, v40, v5 quad_perm:[1,1,1,1] row_mask:0xf bank_mask:0xf
    v_and_b32_dpp v54, v40, v6 quad_perm:[1,1,1,1] row_mask:0xf bank_mask:0xf
    v_and_b32_dpp v55, v40, v7 quad_perm:[1,1,1,1] row_mask:0xf bank_mask:0xf
    v_mfma_f32_16x16x32_bf16 v[28:31], v[48:51], v[112:115], v[28:31]
    v_and_b32_dpp v56, v40, v4 quad_perm:[2,2,2,2] row_mask:0xf bank_mask:0xf
    v_and_b32_dpp v57, v40, v5 quad_perm:[2,2,2,2] row_mask:0xf bank_mask:0xf
    v_and_b32_dpp v58, v40, v6 quad_perm:[2,2,2,2] row_mask:0xf bank_mask:0xf
    v_and_b32_dpp v59, v40, v7 quad_perm:[2,2,2,2] row_mask:0xf bank_mask:0xf
    v_mfma_f32_16x16x32_bf16 v[28:31], v[52:55], v[116:119], v[28:31]
    v_and_b32_dpp v60, v40, v4 quad_perm:[3,3,3,3] row_mask:0xf bank_mask:0xf
    v_and_b32_dpp v61, v40, v5 quad_perm:[3,3,3,3] row_mask:0xf bank_mask:0xf
    v_and_b32_dpp v62, v40, v6 quad_perm:[3,3,3,3] row_mask:0xf bank_mask:0xf
    v_and_b32_dpp v63, v40, v7 quad_perm:[3,3,3,3] row_mask:0xf bank_mask:0xf
    v_mfma_f32_16x16x32_bf16 v[28:31], v[56:59], v[120:123], v[28:31]
    s_nop 0
    v_mfma_f32_16x16x32_bf16 v[28:31], v[60:63], v[124:127], v[28:31]
L_wd:
    s_cmp_eq_u32 s51, 2
    v_mov_b32 v2, 1
    s_mov_b64 exec, 1
    ds_add_u32 v1, v2 offset:36
    s_nop 1
    s_mov_b64 exec, s[34:35]
    s_nop 0
    v_and_or_b32 v28, v28, -2, s44
    v_and_or_b32 v29, v29, -2, s45
    v_and_or_b32 v30, v30, -2, s46
    v_and_or_b32 v31, v31, -2, s47
    s_cbranch_scc1 L_ffar
    global_store_dwordx4 v13, v[28:31], s[30:31]
L_fdone:
    s_branch L_fin
L_t0:
    s_mov_b32 s54, 0
L_st0:
    ds_read_b32 v3, v1 offset:32
    s_add_u32 s54, s54, 1
    s_waitcnt lgkmcnt(0)
    v_readfirstlane_b32 s55, v3
    s_cmp_ge_u32 s55, 8
    s_cbranch_scc1 L_st0_ok
    s_sleep 0
    s_cmp_lt_u32 s54, 131072
    s_cbranch_scc1 L_st0
L_st0_ok:
    global_load_dwordx4 v[104:107], v14, s[30:31] sc1 nt
    s_branch L_tl
L_try:
    global_load_dwordx4 v[104:107], v14, s[30:31] sc1 nt
    ds_read_b128 v[44:47], v9 offset:11904
    s_waitcnt lgkmcnt(0)
    v_cmp_eq_u32 vcc, 1, v44
    s_cbranch_vccnz L_try_no
    s_mov_b32 s41, 1
    v_and_b32 v48, v44, v4
    v_and_b32 v49, v44, v5
    v_and_b32 v50, v44, v6
    v_and_b32 v51, v44, v7
    v_and_b32 v52, v45, v4
    v_and_b32 v53, v45, v5
    v_and_b32 v54, v45, v6
    v_and_b32 v55, v45, v7
    v_mfma_f32_16x16x32_bf16 v[28:31], v[48:51], v[112:115], v[28:31]
    v_and_b32 v56, v46, v4
    v_and_b32 v57, v46, v5
    v_and_b32 v58, v46, v6
    v_and_b32 v59, v46, v7
    v_mfma_f32_16x16x32_bf16 v[28:31], v[52:55], v[116:119], v[28:31]
    v_and_b32 v60, v47, v4
    v_and_b32 v61, v47, v5
    v_and_b32 v62, v47, v6
    v_and_b32 v63, v47, v7
    v_mfma_f32_16x16x32_bf16 v[28:31], v[56:59], v[120:123], v[28:31]
    s_nop 0
    v_mfma_f32_16x16x32_bf16 v[28:31], v[60:63], v[124:127], v[28:31]
L_try_no:
    s_setpc_b64 s[42:43]
L_qw:
    s_sub_u32 s3, s3, 5
    s_lshr_b32 s7, s5, 4
    s_lshl1_add_u32 s7, s7, s3
    s_lshl_b32 s7, s7, 12
    s_add_u32 s7, s7, s32
    s_add_u32 s7, s7, 4096
    v_lshl_add_u32 v8, v0, 4, s7
    v_and_b32 v2, 31, v0
    v_lshrrev_b32 v3, 5, v0
    v_lshl_add_u32 v2, v2, 1, v3
    s_lshl_b32 s6, s3, 8
    v_lshl_add_u32 v9, v2, 2, s6
    v_mov_b32 v10, v8
    s_mov_b32 s54, 0
L_sp:
    ds_read_b32 v3, v1 offset:48
    s_add_u32 s54, s54, 1
    s_waitcnt lgkmcnt(0)
    v_readfirstlane_b32 s55, v3
    s_cmp_ge_u32 s55, 4
    s_cbranch_scc1 L_sp_ok
    s_sleep 2
    s_cmp_lt_u32 s54, 131072
    s_cbranch_scc1 L_sp
L_sp_ok:
    s_mov_b32 s54, 0
L_qg:
    global_load_dwordx4 v[56:59], v10, s[30:31] offset:0 sc1 nt
    global_load_dwordx4 v[60:63], v10, s[30:31] offset:1024 sc1 nt
    global_load_dwordx4 v[64:67], v10, s[30:31] offset:2048 sc1 nt
    global_load_dwordx4 v[68:71], v10, s[30:31] offset:3072 sc1 nt
    s_add_u32 s54, s54, 1
    s_waitcnt vmcnt(3)
    v_perm_b32 v2, v57, v56, s49
    v_perm_b32 v3, v59, v58, s50
    v_or_b32 v2, v2, v3
    v_cmp_eq_u32 vcc, s40, v2
    s_mov_b64 s[52:53], vcc
    s_waitcnt vmcnt(2)
    v_perm_b32 v2, v61, v60, s49
    v_perm_b32 v3, v63, v62, s50
    v_or_b32 v2, v2, v3
    v_cmp_eq_u32 vcc, s40, v2
    s_and_b64 s[52:53], s[52:53], vcc
    s_waitcnt vmcnt(1)
    v_perm_b32 v2, v65, v64, s49
    v_perm_b32 v3, v67, v66, s50
    v_or_b32 v2, v2, v3
    v_cmp_eq_u32 vcc, s40, v2
    s_and_b64 s[52:53], s[52:53], vcc
    s_waitcnt vmcnt(0)
    v_perm_b32 v2, v69, v68, s49
    v_perm_b32 v3, v71, v70, s50
    v_or_b32 v2, v2, v3
    v_cmp_eq_u32 vcc, s40, v2
    s_and_b64 s[52:53], s[52:53], vcc
    s_cmp_eq_u64 s[52:53], -1
    s_cbranch_scc1 L_qg_ok
    ds_read_b32 v3, v1 offset:40
    s_waitcnt lgkmcnt(0)
    v_readfirstlane_b32 s55, v3
    s_cmp_eq_u32 s55, 2
    s_cbranch_scc0 L_rp1
    v_add_u32 v19, 1048576, v18
    s_mov_b64 exec, s[34:35]
    global_store_dwordx4 v19, v[28:31], s[30:31] sc1
    s_mov_b64 exec, -1
L_rp1:
    s_cmp_eq_u32 s55, 2
    s_cselect_b32 s36, 1048576, 0
    v_add_u32 v10, s36, v8
    s_cmp_lt_u32 s54, 131072
    s_cbranch_scc1 L_qg
L_qg_ok:
    v_and_b32 v56, s48, v56
    v_and_b32 v57, s48, v57
    v_and_b32 v58, s48, v58
    v_and_b32 v59, s48, v59
    v_and_b32 v60, s48, v60
    v_and_b32 v61, s48, v61
    v_and_b32 v62, s48, v62
    v_and_b32 v63, s48, v63
    v_and_b32 v64, s48, v64
    v_and_b32 v65, s48, v65
    v_and_b32 v66, s48, v66
    v_and_b32 v67, s48, v67
    v_and_b32 v68, s48, v68
    v_and_b32 v69, s48, v69
    v_and_b32 v70, s48, v70
    v_and_b32 v71, s48, v71
    v_add_f32 v56, v56, v60
    v_add_f32 v57, v57, v61
    v_add_f32 v58, v58, v62
    v_add_f32 v59, v59, v63
    v_add_f32 v64, v64, v68
    v_add_f32 v65, v65, v69
    v_add_f32 v66, v66, v70
    v_add_f32 v67, v67, v71
    v_add_f32 v56, v56, v64
    v_add_f32 v57, v57, v65
    v_add_f32 v58, v58, v66
    v_add_f32 v59, v59, v67
    s_nop 0
    v_permlane32_swap_b32 v56, v58
    v_permlane32_swap_b32 v57, v59
    v_add_f32 v56, v56, v58
    v_add_f32 v57, v57, v59
    v_cvt_pk_bf16_f32 v56, v56, v57
    ds_write_b32 v9, v56 offset:320
    s_mov_b64 exec, 1
    ds_add_u32 v1, v32 offset:16
    s_mov_b64 exec, -1
    s_mov_b32 s54, 0
L_sm1:
    ds_read_b32 v3, v1 offset:40
    s_add_u32 s54, s54, 1
    s_waitcnt lgkmcnt(0)
    v_readfirstlane_b32 s55, v3
    s_cmp_ge_u32 s55, 1
    s_cbranch_scc1 L_sm1_ok
    s_sleep 4
    s_cmp_lt_u32 s54, 131072
    s_cbranch_scc1 L_sm1
L_sm1_ok:
    s_cmp_eq_u32 s55, 2
    s_cbranch_scc0 L_rp2
    v_add_u32 v19, 1048576, v18
    s_mov_b64 exec, s[34:35]
    global_store_dwordx4 v19, v[28:31], s[30:31] sc1
    s_mov_b64 exec, -1
L_rp2:
    s_waitcnt vmcnt(0)
    s_mov_b64 exec, 1
    ds_add_u32 v1, v32 offset:44
    s_mov_b64 exec, -1
L_red:
    s_mov_b32 s51, s55
    s_cmp_eq_u32 s55, 2
    s_cselect_b32 s36, 1048576, 0
    s_add_u32 s32, s32, s36
    s_lshl_b32 s33, s3, 5
    s_add_u32 s33, s33, s5
    s_cmp_ge_u32 s33, 72
    s_cbranch_scc1 L_fin
    s_lshl_b32 s34, s33, 10
    s_add_u32 s34, s34, s32
    s_add_u32 s34, s34, 20480
    v_lshl_add_u32 v8, v0, 4, s34
    s_lshl_b32 s34, s33, 6
    s_add_u32 s34, s34, 2101248
    v_lshrrev_b32 v3, 4, v0
    v_and_b32 v2, 3, v0
    v_lshlrev_b32 v12, 2, v2
    v_lshl_add_u32 v12, v3, 4, v12
    v_add_u32 v9, s34, v12
    v_lshl_add_u32 v16, v2, 4, s34
    v_and_b32 v12, 4, v0
    v_lshl_add_u32 v16, v12, 10, v16
    v_and_b32 v12, 1, v0
    v_lshlrev_b32 v12, 4, v12
    v_lshl_add_u32 v12, v3, 1, v12
    s_lshr_b32 s34, s33, 1
    s_lshl_b32 s34, s34, 5
    s_and_b32 s35, s33, 1
    s_lshl3_add_u32 s34, s35, s34
    v_add_u32 v10, s34, v12
    global_load_ushort v11, v10, s[8:9]
    s_andn2_b32 s41, 0x01010101, s40
    s_mov_b32 s58, 0x01010101
    s_and_b32 s42, s40, 0x007ffff0
    s_or_b32 s42, s42, 0x4b000000
    s_lshr_b32 s43, s40, 9
    s_or_b32 s43, s43, 0x4b000000
    s_mov_b32 s34, 0x000c000c
    s_mov_b32 s35, 0x000c000c
    s_mov_b32 s36, 0x00010001
    s_mov_b32 s37, 0x00010001
    v_cmp_eq_u32 vcc, 2, v2
    v_mov_b32 v13, s43
    v_mov_b32 v14, s42
    v_cndmask_b32 v13, v13, v14, vcc
    v_cndmask_b32 v15, 0, 1.0, vcc
    v_cndmask_b32 v18, 0, 7, vcc
    s_and_b32 s38, s33, 0x47
    s_cmp_eq_u32 s38, s4
    s_cbranch_scc0 L_nzi
    v_mov_b32 v44, 0
    v_mov_b32 v45, 0
    v_mov_b32 v46, s42
    v_mov_b32 v47, s43
    s_cmp_lt_u32 s33, 8
    s_cselect_b64 exec, 0xff, 15
    global_store_dwordx4 v16, v[44:47], s[30:31] sc1
    s_mov_b64 exec, -1
L_nzi:
    s_mov_b32 s54, 0
L_sr:
    ds_read_b32 v3, v1 offset:44
    s_add_u32 s54, s54, 1
    s_waitcnt lgkmcnt(0)
    v_readfirstlane_b32 s55, v3
    s_cmp_ge_u32 s55, 8
    s_cbranch_scc1 L_sr_ok
    s_sleep 2
    s_cmp_lt_u32 s54, 131072
    s_cbranch_scc1 L_sr
L_sr_ok:
    s_mov_b32 s54, 0
L_sl:
    ds_read_b32 v3, v1 offset:20
    s_add_u32 s54, s54, 1
    s_waitcnt lgkmcnt(0)
    v_readfirstlane_b32 s55, v3
    s_cmp_ge_u32 s55, 8
    s_cbranch_scc1 L_sl_ok
    s_sleep 1
    s_cmp_lt_u32 s54, 131072
    s_cbranch_scc1 L_sl
L_sl_ok:
    s_cmp_eq_u32 s3, 0
    s_cbranch_scc0 L_nst
    ds_read_b64 v[20:21], v1 offset:0
    ds_read_b128 v[24:27], v1 offset:256
    ds_read_b128 v[28:31], v1 offset:272
    ds_read_b128 v[36:39], v1 offset:288
    ds_read_b128 v[40:43], v1 offset:304
    s_lshl_b32 s38, s5, 4
    s_add_u32 s38, s38, s32
    s_add_u32 s38, s38, 126976
    v_mov_b32 v2, s38
    s_waitcnt lgkmcnt(0)
    v_pk_add_f32 v[24:25], v[24:25], v[26:27]
    v_pk_add_f32 v[28:29], v[28:29], v[30:31]
    v_pk_add_f32 v[36:37], v[36:37], v[38:39]
    v_pk_add_f32 v[40:41], v[40:41], v[42:43]
    v_pk_add_f32 v[24:25], v[24:25], v[28:29]
    v_pk_add_f32 v[36:37], v[36:37], v[40:41]
    v_pk_add_f32 v[22:23], v[24:25], v[36:37]
    v_add_u32 v22, 0x80, v22
    v_add_u32 v23, 0x80, v23
    v_perm_b32 v20, v20, v17, s44
    v_perm_b32 v21, v21, v17, s45
    v_perm_b32 v22, v22, v17, s46
    v_perm_b32 v23, v23, v17, s47
    s_mov_b64 exec, 1
    s_cmp_eq_u32 s51, 2
    s_cbranch_scc1 L_mfar
    global_store_dwordx4 v2, v[20:23], s[30:31]
L_mdone:
    ds_write_b32 v1, v32 offset:88
L_nst:
    s_mov_b64 exec, -1
    s_cmp_eq_u32 s3, 2
    s_cbranch_scc1 L_ngt
    s_setprio 3
    v_and_b32 v25, 60, v0
    s_cmp_eq_u32 s3, 1
    s_cbranch_scc1 L_gto
    v_and_b32 v2, 31, v0
    v_lshlrev_b32 v25, 2, v2
    s_and_b32 s38, s5, 16
    v_xor_b32 v2, s38, v2
    s_add_u32 s38, s32, 126976
    v_lshl_add_u32 v26, v2, 4, s38
    v_mov_b32 v27, s48
    s_bitcmp1_b32 s5, 3
    s_cselect_b64 s[56:57], -1, 0
    global_load_dwordx4 v[80:83], v26, s[30:31] sc1 nt
    s_mov_b32 s54, 0
L_mg:
    s_waitcnt vmcnt(0)
    v_perm_b32 v2, v81, v80, s49
    v_perm_b32 v3, v83, v82, s50
    v_or_b32 v2, v2, v3
    v_cmp_eq_u32 vcc, s40, v2
    v_cndmask_b32 v48, v80, v81, s[56:57]
    v_cndmask_b32 v50, v82, v83, s[56:57]
    s_cmp_eq_u64 vcc, -1
    s_cbranch_scc1 L_mg_ok
    global_load_dwordx4 v[80:83], v26, s[30:31] sc1 nt
    s_add_u32 s54, s54, 1
    s_cmp_lt_u32 s54, 131072
    s_cbranch_scc1 L_mg
L_mg_ok:
    v_and_b32 v48, s48, v48
    v_and_b32 v50, s48, v50
    s_nop 0
    v_max_f32_dpp v49, v48, v48 row_ror:8 row_mask:0xf bank_mask:0xf
    s_nop 1
    v_max_f32_dpp v49, v49, v49 row_ror:4 row_mask:0xf bank_mask:0xf
    s_nop 1
    v_max_f32_dpp v49, v49, v49 row_ror:2 row_mask:0xf bank_mask:0xf
    s_nop 1
    v_max_f32_dpp v49, v49, v49 row_ror:1 row_mask:0xf bank_mask:0xf
    v_sub_f32 v48, v48, v49
    v_mul_f32 v48, 0x3fb8aa3b, v48
    v_exp_f32 v24, v48
    s_nop 0
    v_mul_f32 v50, v50, v24
    s_nop 1
    v_add_f32_dpp v50, v50, v50 row_ror:8 row_mask:0xf bank_mask:0xf
    s_nop 1
    v_add_f32_dpp v50, v50, v50 row_ror:4 row_mask:0xf bank_mask:0xf
    s_nop 1
    v_add_f32_dpp v50, v50, v50 row_ror:2 row_mask:0xf bank_mask:0xf
    s_nop 1
    v_add_f32_dpp v50, v50, v50 row_ror:1 row_mask:0xf bank_mask:0xf
    v_rcp_f32 v50, v50
    s_nop 0
    v_mul_f32 v24, v24, v50
    v_and_b32 v24, -2, v24
    ds_write_b32 v25, v24 offset:11968
    s_branch L_ngt
L_gto:
    s_lshl_b32 s38, s5, 10
    s_add_u32 s38, s38, s32
    s_add_u32 s38, s38, 94208
    v_lshl_add_u32 v20, v0, 4, s38
    v_and_b32 v2, 3, v0
    v_and_b32 v3, 48, v0
    v_lshl_add_u32 v23, v2, 2, v3
    global_load_dwordx4 v[80:83], v20, s[30:31] sc1 nt
    s_mov_b32 s54, 0
L_og:
    s_waitcnt vmcnt(0)
    ds_read_b32 v24, v25 offset:11968
    v_perm_b32 v2, v81, v80, s49
    v_perm_b32 v3, v83, v82, s50
    v_or_b32 v2, v2, v3
    v_cmp_eq_u32 vcc, s40, v2
    v_and_b32 v40, s48, v80
    v_and_b32 v41, s48, v81
    v_and_b32 v42, s48, v82
    v_and_b32 v43, s48, v83
    s_cmp_eq_u64 vcc, -1
    s_cbranch_scc1 L_og_ok
    global_load_dwordx4 v[80:83], v20, s[30:31] sc1 nt
    s_add_u32 s54, s54, 1
    s_cmp_lt_u32 s54, 131072
    s_cbranch_scc1 L_og
L_ow:
    ds_read_b32 v24, v25 offset:11968
    s_add_u32 s54, s54, 1
L_og_ok:
    s_waitcnt lgkmcnt(0)
    v_cmp_eq_u32 vcc, 1, v24
    s_cbranch_vccz L_ow_ok
    s_cmp_lt_u32 s54, 1048576
    s_cbranch_scc1 L_ow
L_ow_ok:
    v_mul_f32 v40, v40, v24
    v_mul_f32 v41, v41, v24
    v_mul_f32 v42, v42, v24
    v_mul_f32 v43, v43, v24
    s_nop 0
    v_permlane32_swap_b32 v40, v42
    v_permlane32_swap_b32 v41, v43
    v_add_f32 v40, v40, v42
    v_add_f32 v41, v41, v43
    s_nop 1
    v_permlane16_swap_b32 v40, v41
    v_add_f32 v40, v40, v41
    s_nop 1
    v_add_f32_dpp v40, v40, v40 row_ror:4 row_mask:0xf bank_mask:0xf
    s_nop 1
    v_add_f32_dpp v40, v40, v40 row_ror:8 row_mask:0xf bank_mask:0xf
    v_cvt_pk_bf16_f32 v40, v40, v40
    ds_write_b32 v23, v40 offset:11904
L_ngt:
    s_mov_b32 s54, 0
L_sf:
    ds_read_b32 v3, v1 offset:36
    s_add_u32 s54, s54, 1
    s_waitcnt lgkmcnt(0)
    v_readfirstlane_b32 s55, v3
    s_cmp_ge_u32 s55, 5
    s_cbranch_scc1 L_sf_ok
    s_sleep 0
    s_cmp_lt_u32 s54, 131072
    s_cbranch_scc1 L_sf
L_sf_ok:
    s_mov_b32 s54, 0
    global_load_dwordx4 v[64:67], v8, s[30:31] sc1 nt
    s_sleep 1
    global_load_dwordx4 v[68:71], v8, s[30:31] sc1 nt
    s_sleep 1
L_fg:
    global_load_dwordx4 v[56:59], v8, s[30:31] sc1 nt
    s_waitcnt vmcnt(2)
    v_perm_b32 v2, v65, v64, s49
    v_perm_b32 v3, v67, v66, s50
    v_bitop3_b32 v2, v2, v3, s58 bitop3:0xa8
    v_cmp_eq_u32 vcc, s41, v2
    v_and_b32 v72, -2, v64
    v_and_b32 v73, -2, v65
    v_and_b32 v74, -2, v66
    v_and_b32 v75, -2, v67
    s_cmp_eq_u64 vcc, -1
    s_cbranch_scc1 L_fg_ok
    global_load_dwordx4 v[64:67], v8, s[30:31] sc1 nt
    s_waitcnt vmcnt(2)
    v_perm_b32 v2, v69, v68, s49
    v_perm_b32 v3, v71, v70, s50
    v_bitop3_b32 v2, v2, v3, s58 bitop3:0xa8
    v_cmp_eq_u32 vcc, s41, v2
    v_and_b32 v72, -2, v68
    v_and_b32 v73, -2, v69
    v_and_b32 v74, -2, v70
    v_and_b32 v75, -2, v71
    s_cmp_eq_u64 vcc, -1
    s_cbranch_scc1 L_fg_ok
    global_load_dwordx4 v[68:71], v8, s[30:31] sc1 nt
    s_waitcnt vmcnt(2)
    v_perm_b32 v2, v57, v56, s49
    v_perm_b32 v3, v59, v58, s50
    v_bitop3_b32 v2, v2, v3, s58 bitop3:0xa8
    v_cmp_eq_u32 vcc, s41, v2
    v_and_b32 v72, -2, v56
    v_and_b32 v73, -2, v57
    v_and_b32 v74, -2, v58
    v_and_b32 v75, -2, v59
    s_cmp_eq_u64 vcc, -1
    s_cbranch_scc1 L_fg_ok
    s_add_u32 s54, s54, 1
    s_cmp_lt_u32 s54, 131072
    s_cbranch_scc1 L_fg
L_fg_ok:
    v_permlane32_swap_b32 v72, v74
    v_permlane32_swap_b32 v73, v75
    v_add_f32 v72, v72, v74
    v_add_f32 v73, v73, v75
    v_lshlrev_b32 v11, 16, v11
    s_mov_b32 s38, 0x000f000f
    v_permlane16_swap_b32 v72, v73
    v_add_f32 v72, v72, v73
    s_mov_b32 s39, 0x000f000f
    s_nop 0
    v_add_f32_dpp v72, v72, v72 row_ror:8 row_mask:0xf bank_mask:0xf
    s_nop 1
    v_add_f32_dpp v72, v72, v72 row_ror:4 row_mask:0xf bank_mask:0xf
    s_nop 1
    v_add_f32_dpp v72, v72, v72 row_ror:2 row_mask:0xf bank_mask:0xf
    v_cndmask_b32 v14, v72, v15, s[34:35]
L_dep:
    s_mov_b64 exec, s[38:39]
    global_atomic_add_f32 v12, v9, v14, s[30:31] sc0 sc1
    v_add_f32 v19, v72, v11
    s_waitcnt vmcnt(0)
    v_sub_u32 v2, v12, v13
    v_add_f32 v12, v12, v19
    v_cmp_eq_u32 s[52:53], v2, v18
    v_cmp_gt_u32 vcc, v2, v18
    v_cvt_pk_bf16_f32 v12, v12, v12
    s_lshr_b64 s[56:57], s[52:53], 1
    s_and_b64 s[52:53], s[52:53], s[56:57]
    s_lshr_b64 s[52:53], s[52:53], 2
    s_and_b64 s[52:53], s[52:53], s[36:37]
    s_lshl_b64 s[56:57], s[52:53], 1
    s_or_b64 exec, s[52:53], s[56:57]
    s_cbranch_execz L_nout
    global_store_short v10, v12, s[26:27]
    s_cmp_eq_u32 s33, 0
    s_cbranch_scc0 L_nout
    s_and_b64 exec, exec, 1
    s_cbranch_execz L_nout
    global_store_dword v1, v17, s[30:31] offset:0
L_nout:
    s_and_b64 s[56:57], vcc, s[34:35]
    s_cbranch_scc0 L_fin
    s_lshr_b64 s[52:53], s[56:57], 1
    s_or_b64 s[52:53], s[52:53], s[56:57]
    s_lshr_b64 s[52:53], s[52:53], 2
    s_and_b64 s[52:53], s[52:53], s[36:37]
    s_mul_i32 s38, s52, 15
    s_mul_i32 s39, s53, 15
    s_add_u32 s54, s54, 1
    s_cmp_lt_u32 s54, 131072
    s_cbranch_scc1 L_dep
    s_branch L_fin
L_ln:
    s_mov_b32 s41, 0xffff0000
    s_waitcnt vmcnt(0)
    v_lshlrev_b32 v20, 16, v8
    v_and_b32 v21, s41, v8
    v_lshlrev_b32 v22, 16, v9
    v_and_b32 v23, s41, v9
    v_lshlrev_b32 v24, 16, v10
    v_and_b32 v25, s41, v10
    v_lshlrev_b32 v26, 16, v11
    v_and_b32 v27, s41, v11
    v_lshlrev_b32 v28, 16, v12
    v_and_b32 v29, s41, v12
    v_lshlrev_b32 v30, 16, v13
    v_and_b32 v31, s41, v13
    v_lshlrev_b32 v32, 16, v14
    v_and_b32 v33, s41, v14
    v_lshlrev_b32 v34, 16, v15
    v_and_b32 v35, s41, v15
    v_add_f32 v2, v20, v21
    v_add_f32 v3, v22, v23
    v_add_f32 v2, v2, v24
    v_add_f32 v3, v3, v25
    v_add_f32 v2, v2, v26
    v_add_f32 v3, v3, v27
    s_mov_b64 exec, 0xff
    v_add_f32 v2, v2, v28
    v_add_f32 v3, v3, v29
    v_add_f32 v2, v2, v30
    v_add_f32 v3, v3, v31
    v_add_f32 v2, v2, v32
    v_add_f32 v3, v3, v33
    v_add_f32 v2, v2, v34
    v_add_f32 v3, v3, v35
    s_mov_b64 exec, -1
    v_add_f32 v2, v2, v3
    s_nop 1
    v_add_f32_dpp v2, v2, v2 row_ror:1 row_mask:0xf bank_mask:0xf
    s_nop 1
    v_add_f32_dpp v2, v2, v2 row_ror:2 row_mask:0xf bank_mask:0xf
    s_nop 1
    v_add_f32_dpp v2, v2, v2 row_ror:4 row_mask:0xf bank_mask:0xf
    s_nop 1
    v_add_f32_dpp v2, v2, v2 row_ror:8 row_mask:0xf bank_mask:0xf
    v_mov_b32 v3, v2
    s_nop 1
    v_permlane16_swap_b32 v2, v3
    v_add_f32 v2, v2, v3
    v_mov_b32 v3, v2
    s_nop 1
    v_permlane32_swap_b32 v2, v3
    v_add_f32 v2, v2, v3
    v_mul_f32 v2, 0x3ae38e39, v2
    v_sub_f32 v40, v20, v2
    v_sub_f32 v41, v21, v2
    v_sub_f32 v42, v22, v2
    v_sub_f32 v43, v23, v2
    v_sub_f32 v44, v24, v2
    v_sub_f32 v45, v25, v2
    v_sub_f32 v46, v26, v2
    v_sub_f32 v47, v27, v2
    v_sub_f32 v48, v28, v2
    v_sub_f32 v49, v29, v2
    v_sub_f32 v50, v30, v2
    v_sub_f32 v51, v31, v2
    v_sub_f32 v52, v32, v2
    v_sub_f32 v53, v33, v2
    v_sub_f32 v54, v34, v2
    v_sub_f32 v55, v35, v2
    v_mul_f32 v3, v40, v40
    v_mul_f32 v16, v41, v41
    v_fmac_f32 v3, v42, v42
    v_fmac_f32 v16, v43, v43
    v_fmac_f32 v3, v44, v44
    v_fmac_f32 v16, v45, v45
    v_fmac_f32 v3, v46, v46
    v_fmac_f32 v16, v47, v47
    s_mov_b64 exec, 0xff
    v_fmac_f32 v3, v48, v48
    v_fmac_f32 v16, v49, v49
    v_fmac_f32 v3, v50, v50
    v_fmac_f32 v16, v51, v51
    v_fmac_f32 v3, v52, v52
    v_fmac_f32 v16, v53, v53
    v_fmac_f32 v3, v54, v54
    v_fmac_f32 v16, v55, v55
    s_mov_b64 exec, -1
    v_add_f32 v3, v3, v16
    s_nop 1
    v_add_f32_dpp v3, v3, v3 row_ror:1 row_mask:0xf bank_mask:0xf
    s_nop 1
    v_add_f32_dpp v3, v3, v3 row_ror:2 row_mask:0xf bank_mask:0xf
    s_nop 1
    v_add_f32_dpp v3, v3, v3 row_ror:4 row_mask:0xf bank_mask:0xf
    s_nop 1
    v_add_f32_dpp v3, v3, v3 row_ror:8 row_mask:0xf bank_mask:0xf
    v_mov_b32 v16, v3
    s_nop 1
    v_permlane16_swap_b32 v3, v16
    v_add_f32 v3, v3, v16
    v_mov_b32 v16, v3
    s_nop 1
    v_permlane32_swap_b32 v3, v16
    v_add_f32 v3, v3, v16
    v_mul_f32 v3, 0x3ae38e39, v3
    v_cvt_pk_bf16_f32 v3, 0, v3
    v_add_f32 v3, 0x3727c5ac, v3
    v_cvt_pk_bf16_f32 v3, 0, v3
    v_sqrt_f32 v3, v3
    v_cvt_pk_bf16_f32 v2, 0, v2
    v_cvt_pk_bf16_f32 v3, 0, v3
    v_rcp_f32 v3, v3
    v_sub_f32 v20, v20, v2
    v_sub_f32 v21, v21, v2
    v_sub_f32 v22, v22, v2
    v_sub_f32 v23, v23, v2
    v_sub_f32 v24, v24, v2
    v_sub_f32 v25, v25, v2
    v_sub_f32 v26, v26, v2
    v_sub_f32 v27, v27, v2
    v_sub_f32 v28, v28, v2
    v_sub_f32 v29, v29, v2
    v_sub_f32 v30, v30, v2
    v_sub_f32 v31, v31, v2
    v_sub_f32 v32, v32, v2
    v_sub_f32 v33, v33, v2
    v_sub_f32 v34, v34, v2
    v_sub_f32 v35, v35, v2
    v_cvt_pk_bf16_f32 v20, 0, v20
    v_cvt_pk_bf16_f32 v21, 0, v21
    v_cvt_pk_bf16_f32 v22, 0, v22
    v_cvt_pk_bf16_f32 v23, 0, v23
    v_cvt_pk_bf16_f32 v24, 0, v24
    v_cvt_pk_bf16_f32 v25, 0, v25
    v_cvt_pk_bf16_f32 v26, 0, v26
    v_cvt_pk_bf16_f32 v27, 0, v27
    v_cvt_pk_bf16_f32 v28, 0, v28
    v_cvt_pk_bf16_f32 v29, 0, v29
    v_cvt_pk_bf16_f32 v30, 0, v30
    v_cvt_pk_bf16_f32 v31, 0, v31
    v_cvt_pk_bf16_f32 v32, 0, v32
    v_cvt_pk_bf16_f32 v33, 0, v33
    v_cvt_pk_bf16_f32 v34, 0, v34
    v_cvt_pk_bf16_f32 v35, 0, v35
    v_mul_f32 v20, v20, v3
    v_mul_f32 v21, v21, v3
    v_mul_f32 v22, v22, v3
    v_mul_f32 v23, v23, v3
    v_mul_f32 v24, v24, v3
    v_mul_f32 v25, v25, v3
    v_mul_f32 v26, v26, v3
    v_mul_f32 v27, v27, v3
    v_mul_f32 v28, v28, v3
    v_mul_f32 v29, v29, v3
    v_mul_f32 v30, v30, v3
    v_mul_f32 v31, v31, v3
    v_mul_f32 v32, v32, v3
    v_mul_f32 v33, v33, v3
    v_mul_f32 v34, v34, v3
    v_mul_f32 v35, v35, v3
    v_cvt_pk_bf16_f32 v20, v20, v20
    v_cvt_pk_bf16_f32 v21, v21, v21
    v_cvt_pk_bf16_f32 v22, v22, v22
    v_cvt_pk_bf16_f32 v23, v23, v23
    v_cvt_pk_bf16_f32 v24, v24, v24
    v_cvt_pk_bf16_f32 v25, v25, v25
    v_cvt_pk_bf16_f32 v26, v26, v26
    v_cvt_pk_bf16_f32 v27, v27, v27
    v_cvt_pk_bf16_f32 v28, v28, v28
    v_cvt_pk_bf16_f32 v29, v29, v29
    v_cvt_pk_bf16_f32 v30, v30, v30
    v_cvt_pk_bf16_f32 v31, v31, v31
    v_cvt_pk_bf16_f32 v32, v32, v32
    v_cvt_pk_bf16_f32 v33, v33, v33
    v_cvt_pk_bf16_f32 v34, v34, v34
    v_cvt_pk_bf16_f32 v35, v35, v35
    v_lshlrev_b32 v2, 5, v0
    v_mov_b32 v1, 0
    ds_write_b128 v2, v[20:23] offset:832
    ds_write_b128 v2, v[24:27] offset:848
    s_mov_b64 exec, 0xff
    ds_write_b128 v2, v[28:31] offset:2880
    ds_write_b128 v2, v[32:35] offset:2896
    s_mov_b64 exec, -1
    s_getreg_b32 s41, hwreg(HW_REG_XCC_ID, 0, 4)
    s_mul_i32 s32, s4, 123520
    s_lshl2_add_u32 s37, s5, s32
    s_add_u32 s37, s37, 127488
    v_mov_b32 v2, s37
    s_waitcnt lgkmcnt(0)
    s_add_u32 s40, s40, 0x9e3779b9
    s_or_b32 s40, s40, 1
    s_mul_i32 s18, s18, 0x85ebca6b
    s_add_u32 s18, s18, s19
    s_mul_i32 s18, s18, 0xc2b2ae35
    s_and_b32 s18, s18, 0xffffff00
    s_add_u32 s40, s40, s18
    v_mov_b32 v17, s40
    s_and_b32 s36, s40, 0xfffffff0
    s_or_b32 s41, s36, s41
    v_mov_b32 v3, s41
    s_barrier
    s_mov_b64 exec, 1
    global_store_dword v2, v3, s[30:31]
    s_and_b32 s36, s5, 7
    s_cmp_eq_u32 s36, s4
    s_cbranch_scc0 L_nct
    s_lshl_b32 s36, s5, 7
    s_add_u32 s36, s36, 2127872
    v_mov_b32 v2, s36
    global_store_dword v2, v17, s[30:31] sc1
L_nct:
    s_mov_b64 exec, -1
    s_mov_b32 s44, 0x07060500
    s_mov_b32 s45, 0x07060501
    s_mov_b32 s46, 0x07060502
    s_mov_b32 s47, 0x07060503
    s_mov_b32 s48, 0xffffff00
    s_mov_b32 s49, 0x0c0c0400
    s_mov_b32 s50, 0x04000c0c
    v_mov_b32 v32, 1
    s_lshr_b32 s6, s5, 1
    s_mul_i32 s6, s6, 9
    s_and_b32 s7, s5, 1
    s_lshl2_add_u32 s6, s7, s6
    s_lshl_b32 s6, s6, 4
    s_mul_i32 s33, s4, 2304
    s_add_u32 s33, s33, s6
    s_add_u32 s33, s33, 2109440
    s_add_u32 s6, s6, s32
    s_add_u32 s6, s6, 20480
    v_and_b32 v2, 7, v0
    v_min_u32 v3, 4, v2
    v_lshrrev_b32 v8, 3, v0
    v_mul_u32_u24 v8, 2304, v8
    v_lshl_add_u32 v3, v3, 4, s6
    v_add_u32 v13, v8, v3
    s_mov_b32 s36, 0
    v_lshrrev_b32 v3, 4, v0
    v_lshlrev_b32 v3, 2, v3
    v_lshl_add_u32 v12, v2, 4, v3
    s_mov_b32 s54, 0
L_sp2:
    ds_read_b32 v3, v1 offset:28
    s_add_u32 s54, s54, 1
    s_waitcnt lgkmcnt(0)
    v_readfirstlane_b32 s55, v3
    s_cmp_ge_u32 s55, 3
    s_cbranch_scc1 L_sp2_ok
    s_sleep 2
    s_cmp_lt_u32 s54, 131072
    s_cbranch_scc1 L_sp2
L_sp2_ok:
    s_mov_b32 s54, 0
L_hg:
    v_add_u32 v8, s36, v13
    v_add_u32 v9, 18432, v8
    v_add_u32 v10, 36864, v8
    v_add_u32 v11, 55296, v8
    global_load_dwordx4 v[36:39], v8, s[30:31] sc1 nt
    global_load_dwordx4 v[40:43], v9, s[30:31] sc1 nt
    global_load_dwordx4 v[44:47], v10, s[30:31] sc1 nt
    global_load_dwordx4 v[48:51], v11, s[30:31] sc1 nt
    s_add_u32 s54, s54, 1
    s_waitcnt vmcnt(3)
    v_perm_b32 v2, v37, v36, s49
    v_perm_b32 v3, v39, v38, s50
    v_or_b32 v2, v2, v3
    v_cmp_eq_u32 vcc, s40, v2
    s_mov_b64 s[52:53], vcc
    s_waitcnt vmcnt(2)
    v_perm_b32 v2, v41, v40, s49
    v_perm_b32 v3, v43, v42, s50
    v_or_b32 v2, v2, v3
    v_cmp_eq_u32 vcc, s40, v2
    s_and_b64 s[52:53], s[52:53], vcc
    s_waitcnt vmcnt(1)
    v_perm_b32 v2, v45, v44, s49
    v_perm_b32 v3, v47, v46, s50
    v_or_b32 v2, v2, v3
    v_cmp_eq_u32 vcc, s40, v2
    s_and_b64 s[52:53], s[52:53], vcc
    s_waitcnt vmcnt(0)
    v_perm_b32 v2, v49, v48, s49
    v_perm_b32 v3, v51, v50, s50
    v_or_b32 v2, v2, v3
    v_cmp_eq_u32 vcc, s40, v2
    s_and_b64 s[52:53], s[52:53], vcc
    s_cmp_eq_u64 s[52:53], -1
    s_cbranch_scc1 L_hg_ok
    ds_read_b32 v3, v1 offset:40
    s_waitcnt lgkmcnt(0)
    v_readfirstlane_b32 s55, v3
    s_cmp_eq_u32 s55, 2
    s_cselect_b32 s36, 1048576, 0
    s_cmp_lt_u32 s54, 131072
    s_cbranch_scc1 L_hg
L_hg_ok:
    v_and_b32 v36, s48, v36
    v_and_b32 v37, s48, v37
    v_and_b32 v38, s48, v38
    v_and_b32 v39, s48, v39
    v_and_b32 v40, s48, v40
    v_and_b32 v41, s48, v41
    v_and_b32 v42, s48, v42
    v_and_b32 v43, s48, v43
    v_and_b32 v44, s48, v44
    v_and_b32 v45, s48, v45
    v_and_b32 v46, s48, v46
    v_and_b32 v47, s48, v47
    v_and_b32 v48, s48, v48
    v_and_b32 v49, s48, v49
    v_and_b32 v50, s48, v50
    v_and_b32 v51, s48, v51
    v_add_f32 v36, v36, v40
    v_add_f32 v44, v44, v48
    v_add_f32 v37, v37, v41
    v_add_f32 v45, v45, v49
    v_add_f32 v38, v38, v42
    v_add_f32 v46, v46, v50
    v_add_f32 v39, v39, v43
    v_add_f32 v47, v47, v51
    v_permlane32_swap_b32 v36, v38
    v_permlane32_swap_b32 v37, v39
    v_permlane32_swap_b32 v44, v46
    v_permlane32_swap_b32 v45, v47
    v_add_f32 v36, v36, v38
    v_add_f32 v37, v37, v39
    v_add_f32 v44, v44, v46
    v_add_f32 v45, v45, v47
    v_permlane16_swap_b32 v36, v37
    s_nop 0
    v_permlane16_swap_b32 v44, v45
    v_add_f32 v36, v36, v37
    v_add_f32 v44, v44, v45
    s_nop 0
    v_add_f32_dpp v20, v36, v36 row_ror:8 row_mask:0xf bank_mask:0xf
    v_add_f32_dpp v28, v44, v44 row_ror:8 row_mask:0xf bank_mask:0xf
    v_cvt_pk_bf16_f32 v20, 0, v20
    v_cvt_pk_bf16_f32 v28, 0, v28
    v_mul_f32 v21, v20, v20
    v_mul_f32 v21, v21, v20
    v_mov_b32 v22, 0x3d372713
    v_fma_f32 v21, v21, v22, v20
    v_mul_f32 v21, 0xc0135761, v21
    v_exp_f32 v21, v21
    s_nop 0
    v_add_f32 v21, 1.0, v21
    v_rcp_f32 v21, v21
    s_nop 0
    v_mul_f32 v21, v20, v21
    v_cvt_pk_bf16_f32 v21, 0, v21
    v_mul_f32 v21, v21, v28
    v_cvt_pk_bf16_f32 v21, v21, v21
    ds_write_b32 v12, v21 offset:128
    v_lshlrev_b32 v2, 4, v0
    v_min_u32 v3, 0x70, v2
    ds_read_b128 v[20:23], v3 offset:128
    s_mov_b64 exec, 1
    ds_add_u32 v1, v32 offset:44
    s_mov_b64 exec, -1
    v_add_u32 v8, s33, v2
    s_mul_i32 s36, s5, 576
    s_add_u32 s36, s36, 2109440
    v_min_u32 v10, 560, v2
    v_add_u32 v9, s36, v10
    s_sub_u32 s36, 31, s7
    s_mov_b32 s37, 0x03020302
    s_waitcnt lgkmcnt(0)
    v_perm_b32 v20, v20, v17, s44
    v_perm_b32 v21, v21, v17, s45
    v_perm_b32 v22, v22, v17, s46
    v_perm_b32 v23, v23, v17, s47
    s_mov_b32 exec_lo, s36
    s_mov_b32 exec_hi, 0
    global_store_dwordx4 v8, v[20:23], s[30:31] sc1
    s_mov_b64 exec, -1
    s_mov_b32 s54, 0
    s_waitcnt vmcnt(0)
    s_mov_b32 s38, 0xfffefffe
    global_load_dwordx4 v[24:27], v9, s[30:31] sc1
L_Hg:
    s_waitcnt vmcnt(0)
    v_perm_b32 v2, v25, v24, s49
    v_perm_b32 v3, v27, v26, s50
    v_or_b32 v2, v2, v3
    v_cmp_eq_u32 vcc, s40, v2
    v_perm_b32 v40, v24, v24, s37
    v_perm_b32 v41, v25, v25, s37
    v_perm_b32 v42, v26, v26, s37
    v_perm_b32 v43, v27, v27, s37
    v_min_u32 v40, s38, v40
    v_min_u32 v41, s38, v41
    v_min_u32 v42, s38, v42
    v_min_u32 v43, s38, v43
    s_mov_b64 exec, vcc
    ds_write_b128 v10, v[40:43] offset:11328
    s_mov_b64 exec, -1
    s_cmp_eq_u64 vcc, -1
    s_cbranch_scc1 L_Hg_ok
    global_load_dwordx4 v[24:27], v9, s[30:31] sc1
    s_add_u32 s54, s54, 1
    s_cmp_lt_u32 s54, 131072
    s_cbranch_scc1 L_Hg
L_Hg_ok:
    s_mov_b32 s54, 0
L_sm3:
    ds_read_b32 v3, v1 offset:40
    s_add_u32 s54, s54, 1
    s_waitcnt lgkmcnt(0)
    v_readfirstlane_b32 s55, v3
    s_cmp_ge_u32 s55, 1
    s_cbranch_scc1 L_sm3_ok
    s_sleep 4
    s_cmp_lt_u32 s54, 131072
    s_cbranch_scc1 L_sm3
L_sm3_ok:
    s_mov_b32 s3, 2
    s_branch L_red
L_kv:
    s_sub_u32 s3, s3, 8
    s_cmp_eq_u32 s3, 0
    s_cbranch_scc0 L_kv1
    v_mov_b32 v3, 0xff800000
    v_cmp_gt_u32 vcc, 2, v0
    v_lshlrev_b32 v1, 2, v0
    s_nop 0
    v_cndmask_b32 v3, 0, v3, vcc
    ds_write_b32 v1, v3
    v_mov_b32 v3, -1
    ds_write_b32 v1, v3 offset:11328
    ds_write_b32 v1, v3 offset:11584
    ds_write_b32 v1, v3 offset:11648
    v_mov_b32 v3, 1
    ds_write_b32 v1, v3 offset:11904
L_kv1:
    s_lshl_b32 s6, s4, 5
    s_add_u32 s6, s6, s5
    s_lshr_b32 s7, s6, 4
    s_lshl_b32 s7, s7, 24
    s_lshl2_add_u32 s32, s3, s5
    s_and_b32 s32, s32, 15
    s_lshl_b32 s32, s32, 10
    s_add_u32 s7, s7, s32
    s_lshl_b32 s32, s3, 14
    s_add_u32 s7, s7, s32
    s_add_u32 s7, s7, 0xf00000
    v_lshl_add_u32 v8, v0, 4, s7
    s_mov_b32 s33, 0x20000
    v_and_b32 v2, 48, v0
    v_lshlrev_b32 v2, 2, v2
    s_lshl_b32 s41, s3, 13
    s_add_u32 s41, s41, 12288
    v_add_u32 v9, s33, v8
    v_add_u32 v10, s33, v9
    v_add_u32 v11, s33, v10
    v_add_u32 v12, s33, v11
    v_add_u32 v13, s33, v12
    v_add_u32 v14, s33, v13
    v_add_u32 v15, s33, v14
    s_bfe_u32 s34, s6, 65540
    s_lshl_b32 s33, s34, 19
    v_xor_b32 v8, s33, v8
    v_xor_b32 v9, s33, v9
    v_xor_b32 v10, s33, v10
    v_xor_b32 v11, s33, v11
    v_xor_b32 v12, s33, v12
    v_xor_b32 v13, s33, v13
    v_xor_b32 v14, s33, v14
    v_xor_b32 v15, s33, v15
    v_xor_b32 v16, v8, v2
    v_xor_b32 v17, v9, v2
    v_xor_b32 v18, v10, v2
    v_xor_b32 v19, v11, v2
    v_xor_b32 v20, v12, v2
    v_xor_b32 v21, v13, v2
    v_xor_b32 v22, v14, v2
    v_xor_b32 v23, v15, v2
    v_xor_b32 v17, 16, v17
    v_xor_b32 v18, 32, v18
    v_xor_b32 v19, 48, v19
    v_xor_b32 v21, 16, v21
    v_xor_b32 v22, 32, v22
    v_xor_b32 v23, 48, v23
    s_mov_b32 m0, s41
    v_mov_b32 v1, 0
    v_mov_b32 v100, 1
    v_and_b32 v4, 1, v0
    v_lshlrev_b32 v4, 4, v4
    v_mov_b32 v5, 0xffff
    v_lshlrev_b32 v3, v4, v5
    v_bfe_u32 v2, v0, 1, 2
    v_cmp_eq_u32 vcc, 0, v2
    s_nop 1
    v_cndmask_b32 v4, 0, v3, vcc
    v_cmp_eq_u32 vcc, 1, v2
    s_nop 1
    v_cndmask_b32 v5, 0, v3, vcc
    v_cmp_eq_u32 vcc, 2, v2
    s_nop 1
    v_cndmask_b32 v6, 0, v3, vcc
    v_cmp_eq_u32 vcc, 3, v2
    s_nop 1
    v_cndmask_b32 v7, 0, v3, vcc
    s_mov_b32 s44, 0x07060500
    s_mov_b32 s45, 0x07060501
    s_mov_b32 s46, 0x07060502
    s_mov_b32 s47, 0x07060503
    s_mov_b32 s48, 0xffffff00
    s_mov_b32 s49, 0x0c0c0400
    s_mov_b32 s50, 0x04000c0c
    v_bfe_u32 v102, v0, 3, 1
    v_and_b32 v2, 48, v0
    v_lshl_add_u32 v101, v102, 8, v2
    v_lshlrev_b32 v103, 2, v102
    s_lshl_b32 s32, s3, 3
    v_add_u32 v104, s32, v103
    v_and_b32 v2, 15, v0
    v_lshlrev_b32 v2, 5, v2
    v_and_b32 v3, 16, v0
    v_add_u32 v2, v2, v3
    v_and_b32 v3, 32, v0
    v_lshl_add_u32 v2, v3, 4, v2
    s_lshl_b32 s32, s3, 10
    v_add_u32 v105, s32, v2
    s_mul_i32 s43, s4, 123520
    s_and_b32 s32, s5, 16
    s_lshl_b32 s33, s32, 10
    s_and_b32 s34, s5, 15
    s_lshl_b32 s35, s34, 6
    s_add_u32 s33, s33, s35
    s_add_u32 s33, s33, s43
    s_add_u32 s33, s33, 94208
    v_lshrrev_b32 v2, 2, v0
    v_lshlrev_b32 v2, 10, v2
    v_and_b32 v3, 3, v0
    v_lshlrev_b32 v3, 4, v3
    v_add3_u32 v106, v2, v3, s33
    v_and_b32 v2, 15, v0
    v_lshrrev_b32 v3, 4, v0
    v_xor_b32 v3, v3, v2
    v_lshlrev_b32 v3, 4, v3
    v_and_b32 v96, 3, v0
    v_lshl_add_u32 v3, v96, 10, v3
    v_and_b32 v2, 12, v0
    v_lshl_add_u32 v3, v2, 6, v3
    v_add_u32 v96, s41, v3
    v_xor_b32 v97, 64, v96
    v_xor_b32 v98, 0x80, v96
    v_xor_b32 v99, 0xc0, v96
    v_lshlrev_b32 v107, 4, v0
    s_mov_b32 s34, 0xff00ff00
    s_mov_b32 s35, 0xff00ff00
    s_mov_b32 s36, 0x01010101
    s_mov_b32 s37, 0x01010101
    s_mov_b32 s38, 0x3db504f3
    s_mov_b32 s39, 0x3fb8aa3b
    s_waitcnt lgkmcnt(0)
    s_load_dword s40, s[30:31], 0
    s_load_dwordx2 s[18:19], s[8:9], 0
    s_barrier
    s_mov_b32 s54, 0
L_sg:
    ds_read_b32 v3, v1 offset:24
    s_add_u32 s54, s54, 1
    s_waitcnt lgkmcnt(0)
    v_readfirstlane_b32 s55, v3
    s_cmp_ge_u32 s55, 2
    s_cbranch_scc1 L_sg_ok
    s_sleep 1
    s_cmp_lt_u32 s54, 131072
    s_cbranch_scc1 L_sg
L_sg_ok:
    s_mov_b32 s54, 0
L_sg2:
    ds_read_b32 v3, v1 offset:60
    s_add_u32 s54, s54, 1
    s_waitcnt lgkmcnt(0)
    v_readfirstlane_b32 s55, v3
    s_cmp_ge_u32 s55, 4
    s_cbranch_scc1 L_sg2_ok
    s_sleep 1
    s_cmp_lt_u32 s54, 131072
    s_cbranch_scc1 L_sg2
L_sg2_ok:
    global_load_lds_dwordx4 v16, s[10:11] nt
    s_add_u32 m0, s41, 1024
    s_nop 0
    global_load_lds_dwordx4 v17, s[10:11] nt
    s_add_u32 m0, s41, 2048
    s_nop 0
    global_load_lds_dwordx4 v18, s[10:11] nt
    s_add_u32 m0, s41, 3072
    s_nop 0
    global_load_lds_dwordx4 v19, s[10:11] nt
    s_add_u32 m0, s41, 4096
    s_waitcnt vmcnt(3)
    global_load_lds_dwordx4 v20, s[10:11] nt
    s_add_u32 m0, s41, 5120
    s_waitcnt vmcnt(3)
    global_load_lds_dwordx4 v21, s[10:11] nt
    s_add_u32 m0, s41, 6144
    s_waitcnt vmcnt(3)
    global_load_lds_dwordx4 v22, s[10:11] nt
    s_add_u32 m0, s41, 7168
    s_waitcnt vmcnt(3)
    global_load_lds_dwordx4 v23, s[10:11] nt
    s_waitcnt vmcnt(3)
    global_load_dwordx4 v[64:67], v8, s[12:13] nt
    s_waitcnt vmcnt(3)
    global_load_dwordx4 v[68:71], v9, s[12:13] nt
    s_waitcnt vmcnt(3)
    global_load_dwordx4 v[72:75], v10, s[12:13] nt
    s_waitcnt vmcnt(3)
    global_load_dwordx4 v[76:79], v11, s[12:13] nt
    s_waitcnt vmcnt(4)
    ds_read_b128 v[32:35], v96 offset:0
    ds_read_b128 v[36:39], v97 offset:0
    ds_read_b128 v[40:43], v98 offset:0
    ds_read_b128 v[44:47], v99 offset:0
    ds_read_b128 v[48:51], v96 offset:4096
    ds_read_b128 v[52:55], v97 offset:4096
    ds_read_b128 v[56:59], v98 offset:4096
    ds_read_b128 v[60:63], v99 offset:4096
    s_mov_b32 s54, 0
    s_mov_b32 s42, 0
L_sq0:
    ds_read_b32 v3, v1 offset:16
    s_add_u32 s54, s54, 1
    s_waitcnt lgkmcnt(0)
    v_readfirstlane_b32 s55, v3
    s_cmp_ge_u32 s55, 2
    s_cbranch_scc1 L_sq_ok
    s_sleep 1
    s_cmp_lt_u32 s54, 6
    s_cbranch_scc1 L_sq0
L_sq_go:
    s_mov_b32 s42, 1
    s_waitcnt vmcnt(3)
    global_load_dwordx4 v[80:83], v12, s[12:13] nt
    s_waitcnt vmcnt(3)
    global_load_dwordx4 v[84:87], v13, s[12:13] nt
    s_waitcnt vmcnt(3)
    global_load_dwordx4 v[88:91], v14, s[12:13] nt
    s_waitcnt vmcnt(3)
    global_load_dwordx4 v[92:95], v15, s[12:13] nt
    s_mov_b64 exec, 1
    ds_add_u32 v1, v100 offset:52
    s_mov_b64 exec, -1
    s_mov_b32 s54, 0
L_sq:
    ds_read_b32 v3, v1 offset:16
    s_add_u32 s54, s54, 1
    s_waitcnt lgkmcnt(0)
    v_readfirstlane_b32 s55, v3
    s_cmp_ge_u32 s55, 2
    s_cbranch_scc1 L_sq_ok
    s_sleep 1
    s_cmp_lt_u32 s54, 131072
    s_cbranch_scc1 L_sq
L_sq_ok:
    ds_read_b128 v[112:115], v101 offset:320
    ds_read_b128 v[116:119], v101 offset:384
    ds_read_b128 v[120:123], v101 offset:448
    ds_read_b128 v[124:127], v101 offset:512
    s_add_u32 s40, s40, 0x9e3779b9
    s_or_b32 s40, s40, 1
    s_mul_i32 s18, s18, 0x85ebca6b
    s_add_u32 s18, s18, s19
    s_mul_i32 s18, s18, 0xc2b2ae35
    s_and_b32 s18, s18, 0xffffff00
    s_add_u32 s40, s40, s18
    v_mov_b32 v108, s40
    s_waitcnt lgkmcnt(0)
    v_mfma_f32_16x16x32_bf16 v[16:19], v[32:35], v[112:115], 0
    v_mfma_f32_16x16x32_bf16 v[20:23], v[48:51], v[112:115], 0
    v_mfma_f32_16x16x32_bf16 v[16:19], v[36:39], v[116:119], v[16:19]
    v_mfma_f32_16x16x32_bf16 v[20:23], v[52:55], v[116:119], v[20:23]
    v_mfma_f32_16x16x32_bf16 v[16:19], v[40:43], v[120:123], v[16:19]
    v_mfma_f32_16x16x32_bf16 v[20:23], v[56:59], v[120:123], v[20:23]
    v_mfma_f32_16x16x32_bf16 v[16:19], v[44:47], v[124:127], v[16:19]
    v_mfma_f32_16x16x32_bf16 v[20:23], v[60:63], v[124:127], v[20:23]
    s_nop 6
    v_cvt_pk_bf16_f32 v16, 0, v16
    v_cvt_pk_bf16_f32 v17, 0, v17
    v_cvt_pk_bf16_f32 v18, 0, v18
    v_cvt_pk_bf16_f32 v19, 0, v19
    v_cvt_pk_bf16_f32 v20, 0, v20
    v_cvt_pk_bf16_f32 v21, 0, v21
    v_cvt_pk_bf16_f32 v22, 0, v22
    v_cvt_pk_bf16_f32 v23, 0, v23
    v_mul_f32 v16, s38, v16
    v_mul_f32 v17, s38, v17
    v_mul_f32 v18, s38, v18
    v_mul_f32 v19, s38, v19
    v_mul_f32 v20, s38, v20
    v_mul_f32 v21, s38, v21
    v_mul_f32 v22, s38, v22
    v_mul_f32 v23, s38, v23
    v_cvt_pk_bf16_f32 v16, 0, v16
    v_cvt_pk_bf16_f32 v17, 0, v17
    v_cvt_pk_bf16_f32 v18, 0, v18
    v_cvt_pk_bf16_f32 v19, 0, v19
    v_cvt_pk_bf16_f32 v20, 0, v20
    v_cvt_pk_bf16_f32 v21, 0, v21
    v_cvt_pk_bf16_f32 v22, 0, v22
    v_cvt_pk_bf16_f32 v23, 0, v23
    v_max3_f32 v24, v16, v17, v18
    v_max3_f32 v25, v19, v20, v21
    v_max3_f32 v24, v24, v22, v23
    v_max_f32 v24, v24, v25
    s_mov_b64 exec, s[36:37]
    ds_max_f32 v103, v24 offset:0
    s_mov_b64 exec, 1
    ds_add_u32 v1, v100 offset:8
    s_mov_b64 exec, -1
    s_mov_b32 s54, 0
L_sm:
    ds_read_b128 v[28:31], v1 offset:0
    s_add_u32 s54, s54, 1
    s_waitcnt lgkmcnt(0)
    v_readfirstlane_b32 s55, v30
    s_cmp_ge_u32 s55, 8
    s_cbranch_scc1 L_sm_ok
    s_sleep 1
    s_cmp_lt_u32 s54, 1
    s_cbranch_scc1 L_sm
L_sm_go:
    s_cmp_eq_u32 s42, 0
    s_cbranch_scc0 L_sm_more
    s_mov_b32 s42, 1
    s_waitcnt vmcnt(3)
    global_load_dwordx4 v[80:83], v12, s[12:13] nt
    s_waitcnt vmcnt(3)
    global_load_dwordx4 v[84:87], v13, s[12:13] nt
    s_waitcnt vmcnt(3)
    global_load_dwordx4 v[88:91], v14, s[12:13] nt
    s_waitcnt vmcnt(3)
    global_load_dwordx4 v[92:95], v15, s[12:13] nt
    s_mov_b64 exec, 1
    ds_add_u32 v1, v100 offset:52
    s_mov_b64 exec, -1
L_sm_more:
    s_cmp_lt_u32 s54, 131072
    s_cbranch_scc1 L_sm
L_sm_ok:
    v_cndmask_b32 v24, v28, v29, s[34:35]
    v_sub_f32 v16, v16, v24
    v_sub_f32 v17, v17, v24
    v_sub_f32 v18, v18, v24
    v_sub_f32 v19, v19, v24
    v_sub_f32 v20, v20, v24
    v_sub_f32 v21, v21, v24
    v_sub_f32 v22, v22, v24
    v_sub_f32 v23, v23, v24
    v_mul_f32 v16, s39, v16
    v_mul_f32 v17, s39, v17
    v_mul_f32 v18, s39, v18
    v_mul_f32 v19, s39, v19
    v_mul_f32 v20, s39, v20
    v_mul_f32 v21, s39, v21
    v_mul_f32 v22, s39, v22
    v_mul_f32 v23, s39, v23
    v_exp_f32 v16, v16
    v_exp_f32 v17, v17
    v_exp_f32 v18, v18
    v_exp_f32 v19, v19
    v_exp_f32 v20, v20
    v_exp_f32 v21, v21
    v_exp_f32 v22, v22
    v_exp_f32 v23, v23
    v_add_f32 v24, v16, v17
    v_add_f32 v25, v18, v19
    v_add_f32 v26, v20, v21
    v_add_f32 v27, v22, v23
    v_add_f32 v24, v24, v25
    v_add_f32 v26, v26, v27
    v_add_f32 v24, v24, v26
    v_mov_b32 v25, v24
    s_nop 1
    v_permlane16_swap_b32 v24, v25
    v_add_f32 v24, v24, v25
    v_mov_b32 v25, v24
    s_nop 1
    v_permlane32_swap_b32 v24, v25
    v_add_f32 v24, v24, v25
    ds_write_b32 v104, v24 offset:256
    s_mov_b64 exec, 1
    ds_add_u32 v1, v100 offset:20
    s_mov_b64 exec, -1
    s_cmp_eq_u32 s42, 0
    s_cbranch_scc0 L_vdone
    s_waitcnt vmcnt(3)
    global_load_dwordx4 v[80:83], v12, s[12:13] nt
    s_waitcnt vmcnt(3)
    global_load_dwordx4 v[84:87], v13, s[12:13] nt
    s_waitcnt vmcnt(3)
    global_load_dwordx4 v[88:91], v14, s[12:13] nt
    s_waitcnt vmcnt(3)
    global_load_dwordx4 v[92:95], v15, s[12:13] nt
    s_mov_b64 exec, 1
    ds_add_u32 v1, v100 offset:52
    s_mov_b64 exec, -1
L_vdone:
    v_cvt_pk_bf16_f32 v16, v16, v16
    v_cvt_pk_bf16_f32 v17, v17, v17
    v_cvt_pk_bf16_f32 v18, v18, v18
    v_cvt_pk_bf16_f32 v19, v19, v19
    v_cvt_pk_bf16_f32 v20, v20, v20
    v_cvt_pk_bf16_f32 v21, v21, v21
    v_cvt_pk_bf16_f32 v22, v22, v22
    v_cvt_pk_bf16_f32 v23, v23, v23
    v_and_b32 v32, v16, v4
    v_and_b32 v33, v16, v5
    v_and_b32 v34, v16, v6
    v_and_b32 v35, v16, v7
    v_and_b32 v36, v17, v4
    v_and_b32 v37, v17, v5
    v_and_b32 v38, v17, v6
    v_and_b32 v39, v17, v7
    v_and_b32 v40, v18, v4
    v_and_b32 v41, v18, v5
    v_and_b32 v42, v18, v6
    v_and_b32 v43, v18, v7
    v_and_b32 v44, v19, v4
    v_and_b32 v45, v19, v5
    v_and_b32 v46, v19, v6
    v_and_b32 v47, v19, v7
    v_and_b32 v48, v20, v4
    v_and_b32 v49, v20, v5
    v_and_b32 v50, v20, v6
    v_and_b32 v51, v20, v7
    v_and_b32 v52, v21, v4
    v_and_b32 v53, v21, v5
    v_and_b32 v54, v21, v6
    v_and_b32 v55, v21, v7
    v_and_b32 v56, v22, v4
    v_and_b32 v57, v22, v5
    v_and_b32 v58, v22, v6
    v_and_b32 v59, v22, v7
    v_and_b32 v60, v23, v4
    v_and_b32 v61, v23, v5
    v_and_b32 v62, v23, v6
    v_and_b32 v63, v23, v7
    s_mov_b32 s54, 0
L_sm2:
    ds_read_b32 v3, v1 offset:40
    s_add_u32 s54, s54, 1
    s_waitcnt lgkmcnt(0)
    v_readfirstlane_b32 s55, v3
    s_cmp_ge_u32 s55, 1
    s_cbranch_scc1 L_sm2_ok
    s_sleep 2
    s_cmp_lt_u32 s54, 131072
    s_cbranch_scc1 L_sm2
L_sm2_ok:
    s_mov_b32 s51, s55
    s_cmp_eq_u32 s55, 2
    s_cselect_b32 s32, 1048576, 0
    v_add_u32 v106, s32, v106
    s_waitcnt vmcnt(7)
    v_mfma_f32_16x16x32_bf16 v[96:99], v[32:35], v[64:67], 0
    s_waitcnt vmcnt(6)
    v_mfma_f32_16x16x32_bf16 v[96:99], v[36:39], v[68:71], v[96:99]
    s_waitcnt vmcnt(5)
    v_mfma_f32_16x16x32_bf16 v[96:99], v[40:43], v[72:75], v[96:99]
    s_waitcnt vmcnt(4)
    v_mfma_f32_16x16x32_bf16 v[96:99], v[44:47], v[76:79], v[96:99]
    s_waitcnt vmcnt(3)
    v_mfma_f32_16x16x32_bf16 v[96:99], v[48:51], v[80:83], v[96:99]
    s_waitcnt vmcnt(2)
    v_mfma_f32_16x16x32_bf16 v[96:99], v[52:55], v[84:87], v[96:99]
    s_waitcnt vmcnt(1)
    v_mfma_f32_16x16x32_bf16 v[96:99], v[56:59], v[88:91], v[96:99]
    s_waitcnt vmcnt(0)
    v_mfma_f32_16x16x32_bf16 v[96:99], v[60:63], v[92:95], v[96:99]
    s_nop 7
    ds_write_b128 v105, v[96:99] offset:3136
    s_mov_b64 exec, 1
    ds_add_rtn_u32 v2, v1, v100 offset:32
    s_mov_b64 exec, -1
    s_waitcnt lgkmcnt(0)
    ds_read_b128 v[32:35], v107 offset:3136
    ds_read_b128 v[36:39], v107 offset:4160
    ds_read_b128 v[40:43], v107 offset:5184
    ds_read_b128 v[44:47], v107 offset:6208
    ds_read_b128 v[48:51], v107 offset:7232
    ds_read_b128 v[52:55], v107 offset:8256
    ds_read_b128 v[56:59], v107 offset:9280
    ds_read_b128 v[60:63], v107 offset:10304
    s_waitcnt lgkmcnt(8)
    v_readfirstlane_b32 s55, v2
    s_cmp_eq_u32 s55, 7
    s_cbranch_scc0 L_fin
    s_waitcnt lgkmcnt(6)
    v_pk_add_f32 v[32:33], v[32:33], v[36:37]
    v_pk_add_f32 v[34:35], v[34:35], v[38:39]
    s_waitcnt lgkmcnt(4)
    v_pk_add_f32 v[40:41], v[40:41], v[44:45]
    v_pk_add_f32 v[42:43], v[42:43], v[46:47]
    v_pk_add_f32 v[32:33], v[32:33], v[40:41]
    v_pk_add_f32 v[34:35], v[34:35], v[42:43]
    s_waitcnt lgkmcnt(2)
    v_pk_add_f32 v[48:49], v[48:49], v[52:53]
    v_pk_add_f32 v[50:51], v[50:51], v[54:55]
    v_pk_add_f32 v[32:33], v[32:33], v[48:49]
    v_pk_add_f32 v[34:35], v[34:35], v[50:51]
    s_waitcnt lgkmcnt(0)
    v_pk_add_f32 v[56:57], v[56:57], v[60:61]
    v_pk_add_f32 v[58:59], v[58:59], v[62:63]
    v_pk_add_f32 v[32:33], v[32:33], v[56:57]
    v_pk_add_f32 v[34:35], v[34:35], v[58:59]
    s_cmp_eq_u32 s51, 2
    v_perm_b32 v32, v32, v108, s44
    v_perm_b32 v33, v33, v108, s45
    v_perm_b32 v34, v34, v108, s46
    v_perm_b32 v35, v35, v108, s47
    s_cbranch_scc1 L_ofar
    global_store_dwordx4 v106, v[32:35], s[30:31]
L_odone:
    s_mov_b64 exec, 1
    ds_add_u32 v1, v100 offset:32
L_fin:
    s_endpgm
L_ofar:
    global_store_dwordx4 v106, v[32:35], s[30:31] sc1
    s_branch L_odone
L_ffar:
    global_store_dwordx4 v13, v[28:31], s[30:31] sc1
    s_branch L_fdone
L_mfar:
    global_store_dwordx4 v2, v[20:23], s[30:31] sc1
    s_branch L_mdone
L_xg_far:
    s_lshl2_add_u32 s36, s5, s32
    s_add_u32 s36, s36, 1176064
    v_mov_b32 v2, s36
    v_mov_b32 v3, s41
    s_mov_b64 exec, 1
    global_store_dword v2, v3, s[30:31] sc1
    s_mov_b32 exec_lo, 0
    s_mov_b32 exec_hi, -1
    v_and_b32 v3, 31, v0
    s_add_u32 s36, s32, 1176064
    v_lshl_add_u32 v8, v3, 2, s36
    s_mov_b64 exec, -1
    s_cmp_eq_u32 s55, 2
    s_cbranch_scc1 L_xg_ok
    s_branch L_xg
L_end:
    s_endpgm
    .fill (L_start + 11776 - .) / 4, 4, 0xbf810000

.section .rodata,"a"
.p2align 6
.amdhsa_kernel parallel_sum__sliding_block_cached__geglu_ffn__decode_kernel
  .amdhsa_next_free_vgpr 128
  .amdhsa_next_free_sgpr 90
  .amdhsa_accum_offset 128
  .amdhsa_group_segment_fixed_size 0
  .amdhsa_kernarg_size 96
  .amdhsa_user_sgpr_count 2
  .amdhsa_user_sgpr_kernarg_segment_ptr 1
  .amdhsa_system_sgpr_workgroup_id_x 1
.end_amdhsa_kernel
```
